```python
import torch

def _softmax(x, axis=-1):
    return torch.softmax(x, dim=axis)
def _gelu(x):
    return torch.nn.functional.gelu(x, approximate="tanh")
def _silu(x):
    return torch.nn.functional.silu(x)
def _sigmoid(x):
    return torch.sigmoid(x)
def _layernorm(x, axis=-1, eps=1e-5):
    m = x.mean(dim=axis, keepdim=True)
    v = x.var(dim=axis, keepdim=True, unbiased=False)
    return (x - m) / torch.sqrt(v + eps)
def _scatter_add(tgt, idx, src, axis=0):
    return tgt.clone().index_add_(axis, idx, src)
def _segment_sum(src, seg, n):
    out = torch.zeros((n,) + src.shape[1:], dtype=src.dtype)
    return out.index_add_(0, seg, src)
def _pad(x, pw):
    flat = tuple(v for pair in reversed(pw) for v in pair)
    return torch.nn.functional.pad(x, flat)

kernel_name = 'standalone__gqa_block_cached__near_ridge'

def setup_inputs():

    _w = (lambda a: (lambda t: t.to(torch.bfloat16) if t.is_floating_point() else t)(torch.as_tensor(a)))
    B, Sq, D = 16, 96, 576
    Hq, Hkv, Sk, Dh = 32, 16, 1024, 128
    assert Hq % Hkv == 0, (Hq, Hkv)
    return {
        "x": _w((lambda *s: torch.randn(*s, dtype=torch.bfloat16) * 0.8)(B, Sq, D)),
        "k_cache": _w((lambda *s: torch.randn(*s, dtype=torch.bfloat16) * 0.8)(B, Hkv, Sk, Dh)),
        "v_cache": _w((lambda *s: torch.randn(*s, dtype=torch.bfloat16) * 0.05)(B, Hkv, Sk, Dh)),
        "wq": _w((lambda *s: torch.randn(*s, dtype=torch.bfloat16) * 0.8)(D, Hq * Dh) * (D ** -0.5)),
        "wo": _w((lambda *s: torch.randn(*s, dtype=torch.bfloat16) * 0.05)(Hq * Dh, D) * ((Hq * Dh) ** -0.5)),
    }

def reference(x, k_cache, v_cache, wq, wo):
    B, Sq, D = x.shape
    Hq, Dh = 32, 128
    Hkv = k_cache.shape[1]
    rep = Hq // Hkv
    q = (lambda x, *d: x.permute(*d))((x @ wq).reshape(B, Sq, Hq, Dh), 0, 2, 1, 3)
    k = (lambda x, n, axis: torch.repeat_interleave(x, n, dim=axis))(k_cache, rep, axis=1)
    v = (lambda x, n, axis: torch.repeat_interleave(x, n, dim=axis))(v_cache, rep, axis=1)
    scores = torch.einsum("bhqd,bhkd->bhqk", q, k) * (Dh ** -0.5)
    p = _softmax(scores, axis=-1)
    o = torch.einsum("bhqk,bhkd->bhqd", p, v)
    return (lambda x, *d: x.permute(*d))(o, 0, 2, 1, 3).reshape(B, Sq, Hq * Dh) @ wo
```

```asm
; @launch grid=(256,1,1) block=(512,1,1) lds=163840
.amdgcn_target "amdgcn-amd-amdhsa--gfx950"
.text
.globl standalone__gqa_block_cached__near_ridge_kernel
.p2align 8
.type standalone__gqa_block_cached__near_ridge_kernel,@function
standalone__gqa_block_cached__near_ridge_kernel:
    s_cmp_ge_u32 s2, 256
    s_cbranch_scc1 L_k1_end
    s_load_dwordx8 s[4:11], s[0:1], 0
    s_load_dwordx4 s[12:15], s[0:1], 32
    s_load_dwordx4 s[16:19], s[0:1], 48
    v_lshrrev_b32 v1, 6, v0
    s_and_b32 s67, s2, 7
    s_lshr_b32 s68, s2, 3
    v_readfirstlane_b32 s44, v1
    s_and_b32 s45, s67, 1
    s_lshl_b32 s45, s45, 3
    s_and_b32 s50, s68, 7
    s_add_u32 s45, s45, s50
    s_lshr_b32 s46, s67, 1
    s_lshl_b32 s46, s46, 2
    s_lshr_b32 s50, s68, 3
    s_add_u32 s46, s46, s50
    v_and_b32 v1, 63, v0
    s_sub_u32 s47, s44, 4
    s_cmp_lt_u32 s47, 2
    s_cbranch_scc0 L_notw
    v_lshrrev_b32 v6, 5, v1
    v_and_b32 v7, 31, v1
    s_lshl_b32 s49, s47, 17
    v_lshlrev_b32 v8, 13, v6
    v_add_u32 v8, s49, v8
    v_add_u32 v5, 0, v6
    v_lshlrev_b32 v5, 1, v5
    v_xor_b32 v5, v5, v7
    v_lshlrev_b32 v5, 4, v5
    v_add_u32 v10, v8, v5
    v_add_u32 v5, 2, v6
    v_lshlrev_b32 v5, 1, v5
    v_xor_b32 v5, v5, v7
    v_lshlrev_b32 v5, 4, v5
    v_add_u32 v11, v8, v5
    v_add_u32 v5, 4, v6
    v_lshlrev_b32 v5, 1, v5
    v_xor_b32 v5, v5, v7
    v_lshlrev_b32 v5, 4, v5
    v_add_u32 v12, v8, v5
    v_add_u32 v5, 6, v6
    v_lshlrev_b32 v5, 1, v5
    v_xor_b32 v5, v5, v7
    v_lshlrev_b32 v5, 4, v5
    v_add_u32 v13, v8, v5
    v_lshrrev_b32 v6, 3, v1
    v_and_b32 v7, 7, v1
    s_mul_i32 s49, s47, 48
    v_add_u32 v8, s49, v6
    v_mul_u32_u24 v8, 1152, v8
    v_lshrrev_b32 v9, 1, v6
    v_add_u32 v5, 0, v9
    v_xor_b32 v5, v5, v7
    v_lshlrev_b32 v5, 4, v5
    v_add_u32 v14, v8, v5
    v_add_u32 v5, 4, v9
    v_xor_b32 v5, v5, v7
    v_lshlrev_b32 v5, 4, v5
    v_add_u32 v15, v8, v5
    v_mul_u32_u24 v8, 1152, v6
    v_and_b32 v5, 3, v9
    v_lshlrev_b32 v5, 1, v5
    v_xor_b32 v5, v5, v7
    v_lshlrev_b32 v5, 4, v5
    v_add_u32 v16, v8, v5
    s_lshl_b32 s52, s47, 13
    s_mul_i32 s59, s47, 6144
    s_lshl_b32 s66, s47, 14
    s_mul_i32 s53, s47, 147456
    s_and_b32 s48, s68, 7
    s_lshr_b32 s48, s48, 0
    s_mul_i32 s48, s48, 1
    s_lshr_b32 s49, s68, 3
    s_mul_i32 s49, s49, 2
    s_add_u32 s48, s48, s49
    s_cmp_ge_u32 s48, 9
    s_cselect_b32 s49, 9, 0
    s_sub_u32 s48, s48, s49
    s_cmp_ge_u32 s48, 9
    s_cselect_b32 s49, 9, 0
    s_sub_u32 s48, s48, s49
    s_lshl_b32 s98, s48, 19
    s_lshl_b32 s99, s48, 7
    s_and_b32 s48, s45, 7
    s_lshl_b32 s100, s48, 7
    s_mov_b32 s93, 32768
    s_mov_b32 s92, 0
    s_mov_b32 s91, 0
    s_add_u32 s52, s52, 71680
    s_add_u32 s59, s59, 137216
    s_waitcnt lgkmcnt(0)
    s_mul_i32 s49, s45, 110592
    s_add_u32 s28, s4, s49
    s_addc_u32 s29, s5, 0
    s_mov_b32 s30, 110592
    s_mov_b32 s31, 0x20000
    s_lshl_b32 s49, s46, 9
    s_add_u32 s32, s10, s49
    s_addc_u32 s33, s11, 0
    s_mov_b32 s34, 0
    s_mov_b32 s35, 0x20000
    s_sub_u32 s34, 4718592, s49
    s_mov_b32 s55, 0
Lwi_1:
    s_add_u32 m0, s59, s92
    s_add_u32 s48, s99, 0
    buffer_load_dwordx4 v14, s[28:31], s48 offen offset:0 lds
    s_add_u32 s48, s99, 8192
    buffer_load_dwordx4 v15, s[28:31], s48 offen offset:1024 lds
    s_add_u32 s48, s99, 16384
    buffer_load_dwordx4 v14, s[28:31], s48 offen offset:2048 lds
    s_add_u32 s48, s99, 24576
    buffer_load_dwordx4 v15, s[28:31], s48 offen offset:3072 lds
    s_add_u32 m0, m0, 4096
    s_add_u32 s48, s99, 36864
    buffer_load_dwordx4 v14, s[28:31], s48 offen offset:0 lds
    s_add_u32 s48, s99, 45056
    buffer_load_dwordx4 v15, s[28:31], s48 offen offset:1024 lds
    s_add_u32 s99, s99, 128
    s_cmp_eq_u32 s99, 1152
    s_cselect_b32 s99, 0, s99
    s_xor_b32 s92, s92, 12288
    s_add_u32 m0, s52, s93
    s_add_u32 s48, s98, 0
    buffer_load_dwordx4 v10, s[32:35], s48 offen offset:0 lds
    s_add_u32 s48, s98, 15360
    buffer_load_dwordx4 v11, s[32:35], s48 offen offset:1024 lds
    s_add_u32 s48, s98, 30720
    buffer_load_dwordx4 v10, s[32:35], s48 offen offset:2048 lds
    s_add_u32 s48, s98, 46080
    buffer_load_dwordx4 v11, s[32:35], s48 offen offset:3072 lds
    s_add_u32 m0, m0, 4096
    s_add_u32 s48, s98, 65536
    buffer_load_dwordx4 v12, s[32:35], s48 offen offset:0 lds
    s_add_u32 s48, s98, 80896
    buffer_load_dwordx4 v13, s[32:35], s48 offen offset:1024 lds
    s_add_u32 s48, s98, 96256
    buffer_load_dwordx4 v12, s[32:35], s48 offen offset:2048 lds
    s_add_u32 s48, s98, 111616
    buffer_load_dwordx4 v13, s[32:35], s48 offen offset:3072 lds
    s_add_u32 s98, s98, 262144
    s_cmp_eq_u32 s98, 4718592
    s_cselect_b32 s98, 0, s98
    s_add_u32 s93, s93, 16384
    s_cmp_eq_u32 s93, 65536
    s_cselect_b32 s93, 0, s93
    s_add_u32 m0, s52, s93
    s_add_u32 s48, s98, 0
    buffer_load_dwordx4 v10, s[32:35], s48 offen offset:0 lds
    s_add_u32 s48, s98, 15360
    buffer_load_dwordx4 v11, s[32:35], s48 offen offset:1024 lds
    s_add_u32 s48, s98, 30720
    buffer_load_dwordx4 v10, s[32:35], s48 offen offset:2048 lds
    s_add_u32 s48, s98, 46080
    buffer_load_dwordx4 v11, s[32:35], s48 offen offset:3072 lds
    s_add_u32 m0, m0, 4096
    s_add_u32 s48, s98, 65536
    buffer_load_dwordx4 v12, s[32:35], s48 offen offset:0 lds
    s_add_u32 s48, s98, 80896
    buffer_load_dwordx4 v13, s[32:35], s48 offen offset:1024 lds
    s_add_u32 s48, s98, 96256
    buffer_load_dwordx4 v12, s[32:35], s48 offen offset:2048 lds
    s_add_u32 s48, s98, 111616
    buffer_load_dwordx4 v13, s[32:35], s48 offen offset:3072 lds
    s_add_u32 s98, s98, 262144
    s_cmp_eq_u32 s98, 4718592
    s_cselect_b32 s98, 0, s98
    s_add_u32 s93, s93, 16384
    s_cmp_eq_u32 s93, 65536
    s_cselect_b32 s93, 0, s93
    s_cmp_lg_u32 s55, 0
    s_cbranch_scc1 Lwi0_2
    s_lshl_b32 s48, s45, 4
    s_add_u32 s48, s48, s46
    s_mul_i32 s49, s46, 294912
    s_add_u32 s36, s12, s49
    s_addc_u32 s37, s13, 0
    s_mov_b32 s38, 294912
    s_mov_b32 s39, 0x20000
    s_mul_i32 s49, s45, 110592
    s_add_u32 s12, s14, s49
    s_addc_u32 s13, s15, 0
    s_mov_b32 s14, 110592
    s_mov_b32 s15, 0x20000
    s_mul_i32 s49, s45, 1769472
    s_add_u32 s49, s49, 1048576
    s_add_u32 s4, s18, s49
    s_addc_u32 s5, s19, 0
    s_mov_b32 s6, 1769472
    s_mov_b32 s7, 0x20000
    s_mul_i32 s49, s45, 1152
    s_add_u32 s49, s49, 524288
    s_add_u32 s8, s18, s49
    s_addc_u32 s9, s19, 0
    s_mov_b32 s10, 1152
    s_mov_b32 s11, 0x20000
    s_waitcnt vmcnt(8)
    s_barrier
    s_mov_b32 s55, 1
    s_branch Lwi_1
Lwi0_2:
    s_waitcnt vmcnt(22)
    s_barrier
    s_add_u32 m0, s52, s93
    s_add_u32 s48, s98, 0
    buffer_load_dwordx4 v10, s[32:35], s48 offen offset:0 lds
    s_add_u32 s48, s98, 15360
    buffer_load_dwordx4 v11, s[32:35], s48 offen offset:1024 lds
    s_add_u32 s48, s98, 30720
    buffer_load_dwordx4 v10, s[32:35], s48 offen offset:2048 lds
    s_add_u32 s48, s98, 46080
    buffer_load_dwordx4 v11, s[32:35], s48 offen offset:3072 lds
    s_add_u32 m0, m0, 4096
    s_add_u32 s48, s98, 65536
    buffer_load_dwordx4 v12, s[32:35], s48 offen offset:0 lds
    s_add_u32 s48, s98, 80896
    buffer_load_dwordx4 v13, s[32:35], s48 offen offset:1024 lds
    s_add_u32 s48, s98, 96256
    buffer_load_dwordx4 v12, s[32:35], s48 offen offset:2048 lds
    s_add_u32 s48, s98, 111616
    buffer_load_dwordx4 v13, s[32:35], s48 offen offset:3072 lds
    s_add_u32 s98, s98, 262144
    s_cmp_eq_u32 s98, 4718592
    s_cselect_b32 s98, 0, s98
    s_add_u32 s93, s93, 16384
    s_cmp_eq_u32 s93, 65536
    s_cselect_b32 s93, 0, s93
    s_mov_b32 s55, 0
Lwq_3:
    s_waitcnt vmcnt(16)
    s_barrier
    s_add_u32 m0, s59, s92
    s_add_u32 s48, s99, 0
    buffer_load_dwordx4 v14, s[28:31], s48 offen offset:0 lds
    s_add_u32 s48, s99, 8192
    buffer_load_dwordx4 v15, s[28:31], s48 offen offset:1024 lds
    s_add_u32 s48, s99, 16384
    buffer_load_dwordx4 v14, s[28:31], s48 offen offset:2048 lds
    s_add_u32 s48, s99, 24576
    buffer_load_dwordx4 v15, s[28:31], s48 offen offset:3072 lds
    s_add_u32 m0, m0, 4096
    s_add_u32 s48, s99, 36864
    buffer_load_dwordx4 v14, s[28:31], s48 offen offset:0 lds
    s_add_u32 s48, s99, 45056
    buffer_load_dwordx4 v15, s[28:31], s48 offen offset:1024 lds
    s_add_u32 s99, s99, 128
    s_cmp_eq_u32 s99, 1152
    s_cselect_b32 s99, 0, s99
    s_xor_b32 s92, s92, 12288
    s_add_u32 m0, s52, s93
    s_add_u32 s48, s98, 0
    buffer_load_dwordx4 v10, s[32:35], s48 offen offset:0 lds
    s_add_u32 s48, s98, 15360
    buffer_load_dwordx4 v11, s[32:35], s48 offen offset:1024 lds
    s_add_u32 s48, s98, 30720
    buffer_load_dwordx4 v10, s[32:35], s48 offen offset:2048 lds
    s_add_u32 s48, s98, 46080
    buffer_load_dwordx4 v11, s[32:35], s48 offen offset:3072 lds
    s_add_u32 m0, m0, 4096
    s_add_u32 s48, s98, 65536
    buffer_load_dwordx4 v12, s[32:35], s48 offen offset:0 lds
    s_add_u32 s48, s98, 80896
    buffer_load_dwordx4 v13, s[32:35], s48 offen offset:1024 lds
    s_add_u32 s48, s98, 96256
    buffer_load_dwordx4 v12, s[32:35], s48 offen offset:2048 lds
    s_add_u32 s48, s98, 111616
    buffer_load_dwordx4 v13, s[32:35], s48 offen offset:3072 lds
    s_add_u32 s98, s98, 262144
    s_cmp_eq_u32 s98, 4718592
    s_cselect_b32 s98, 0, s98
    s_add_u32 s93, s93, 16384
    s_cmp_eq_u32 s93, 65536
    s_cselect_b32 s93, 0, s93
    s_waitcnt vmcnt(22)
    s_barrier
    s_cmp_eq_u32 s55, 6
    s_cbranch_scc1 Lwl_4
    s_add_u32 m0, s52, s93
    s_add_u32 s48, s98, 0
    buffer_load_dwordx4 v10, s[32:35], s48 offen offset:0 lds
    s_add_u32 s48, s98, 15360
    buffer_load_dwordx4 v11, s[32:35], s48 offen offset:1024 lds
    s_add_u32 s48, s98, 30720
    buffer_load_dwordx4 v10, s[32:35], s48 offen offset:2048 lds
    s_add_u32 s48, s98, 46080
    buffer_load_dwordx4 v11, s[32:35], s48 offen offset:3072 lds
    s_add_u32 m0, m0, 4096
    s_add_u32 s48, s98, 65536
    buffer_load_dwordx4 v12, s[32:35], s48 offen offset:0 lds
    s_add_u32 s48, s98, 80896
    buffer_load_dwordx4 v13, s[32:35], s48 offen offset:1024 lds
    s_add_u32 s48, s98, 96256
    buffer_load_dwordx4 v12, s[32:35], s48 offen offset:2048 lds
    s_add_u32 s48, s98, 111616
    buffer_load_dwordx4 v13, s[32:35], s48 offen offset:3072 lds
    s_add_u32 s98, s98, 262144
    s_cmp_eq_u32 s98, 4718592
    s_cselect_b32 s98, 0, s98
    s_add_u32 s93, s93, 16384
    s_cmp_eq_u32 s93, 65536
    s_cselect_b32 s93, 0, s93
Lwl_4:
    s_add_u32 s55, s55, 1
    s_cmp_lt_u32 s55, 7
    s_cbranch_scc1 Lwq_3
    s_waitcnt vmcnt(8)
    s_barrier
    s_waitcnt vmcnt(0)
    s_barrier
    s_barrier
    s_barrier
    s_mov_b32 s55, 0
Lwa_5:
    s_barrier
    s_add_u32 s55, s55, 1
    s_cmp_lt_u32 s55, 11
    s_cbranch_scc1 Lwa_5
    s_cmp_lg_u32 s47, 1
    s_cbranch_scc1 Lcp_6
    s_getpc_b64 s[94:95]
Lcpf_7:
    s_sub_u32 s94, s94, (Lcpf_7 - standalone__gqa_block_cached__near_ridge_kernel)
    s_subb_u32 s95, s95, 0
    s_lshl_b32 s48, s68, 11
    v_and_b32 v34, 15, v1
    v_lshlrev_b32 v34, 7, v34
    v_add_u32 v34, s48, v34
    v_min_u32 v34, (L_k1_end - standalone__gqa_block_cached__near_ridge_kernel), v34
    global_load_dword v35, v34, s[94:95]
Lcp_6:
    s_mov_b32 s55, 0
Lwb_8:
    s_barrier
    s_add_u32 s55, s55, 1
    s_cmp_lt_u32 s55, 2
    s_cbranch_scc1 Lwb_8
    s_mov_b32 s55, 0
Lwo_9:
    s_barrier
    s_add_u32 s49, s53, s100
    s_add_u32 m0, s66, s91
    s_add_u32 s48, s49, 0
    buffer_load_dwordx4 v16, s[36:39], s48 offen offset:0 lds
    s_add_u32 s48, s49, 8192
    buffer_load_dwordx4 v16, s[36:39], s48 offen offset:1024 lds
    s_add_u32 s48, s49, 16384
    buffer_load_dwordx4 v16, s[36:39], s48 offen offset:2048 lds
    s_add_u32 s48, s49, 24576
    buffer_load_dwordx4 v16, s[36:39], s48 offen offset:3072 lds
    s_add_u32 m0, m0, 4096
    s_add_u32 s48, s49, 36864
    buffer_load_dwordx4 v16, s[36:39], s48 offen offset:0 lds
    s_add_u32 s48, s49, 45056
    buffer_load_dwordx4 v16, s[36:39], s48 offen offset:1024 lds
    s_add_u32 s48, s49, 53248
    buffer_load_dwordx4 v16, s[36:39], s48 offen offset:2048 lds
    s_add_u32 s48, s49, 61440
    buffer_load_dwordx4 v16, s[36:39], s48 offen offset:3072 lds
    s_add_u32 m0, m0, 4096
    s_add_u32 s48, s49, 73728
    buffer_load_dwordx4 v16, s[36:39], s48 offen offset:0 lds
    s_add_u32 s48, s49, 81920
    buffer_load_dwordx4 v16, s[36:39], s48 offen offset:1024 lds
    s_add_u32 s48, s49, 90112
    buffer_load_dwordx4 v16, s[36:39], s48 offen offset:2048 lds
    s_add_u32 s48, s49, 98304
    buffer_load_dwordx4 v16, s[36:39], s48 offen offset:3072 lds
    s_add_u32 m0, m0, 4096
    s_add_u32 s48, s49, 110592
    buffer_load_dwordx4 v16, s[36:39], s48 offen offset:0 lds
    s_add_u32 s48, s49, 118784
    buffer_load_dwordx4 v16, s[36:39], s48 offen offset:1024 lds
    s_add_u32 s48, s49, 126976
    buffer_load_dwordx4 v16, s[36:39], s48 offen offset:2048 lds
    s_add_u32 s48, s49, 135168
    buffer_load_dwordx4 v16, s[36:39], s48 offen offset:3072 lds
    s_add_u32 s100, s100, 128
    s_cmp_eq_u32 s100, 1152
    s_cselect_b32 s100, 0, s100
    s_add_u32 s91, s91, 35840
    s_cmp_eq_u32 s91, 143360
    s_cselect_b32 s91, 0, s91
    s_add_u32 s55, s55, 1
    s_cmp_lt_u32 s55, 2
    s_cbranch_scc1 Lwo_9
    s_waitcnt vmcnt(16)
    s_barrier
    s_add_u32 s49, s53, s100
    s_add_u32 m0, s66, s91
    s_add_u32 s48, s49, 0
    buffer_load_dwordx4 v16, s[36:39], s48 offen offset:0 lds
    s_add_u32 s48, s49, 8192
    buffer_load_dwordx4 v16, s[36:39], s48 offen offset:1024 lds
    s_add_u32 s48, s49, 16384
    buffer_load_dwordx4 v16, s[36:39], s48 offen offset:2048 lds
    s_add_u32 s48, s49, 24576
    buffer_load_dwordx4 v16, s[36:39], s48 offen offset:3072 lds
    s_add_u32 m0, m0, 4096
    s_add_u32 s48, s49, 36864
    buffer_load_dwordx4 v16, s[36:39], s48 offen offset:0 lds
    s_add_u32 s48, s49, 45056
    buffer_load_dwordx4 v16, s[36:39], s48 offen offset:1024 lds
    s_add_u32 s48, s49, 53248
    buffer_load_dwordx4 v16, s[36:39], s48 offen offset:2048 lds
    s_add_u32 s48, s49, 61440
    buffer_load_dwordx4 v16, s[36:39], s48 offen offset:3072 lds
    s_add_u32 m0, m0, 4096
    s_add_u32 s48, s49, 73728
    buffer_load_dwordx4 v16, s[36:39], s48 offen offset:0 lds
    s_add_u32 s48, s49, 81920
    buffer_load_dwordx4 v16, s[36:39], s48 offen offset:1024 lds
    s_add_u32 s48, s49, 90112
    buffer_load_dwordx4 v16, s[36:39], s48 offen offset:2048 lds
    s_add_u32 s48, s49, 98304
    buffer_load_dwordx4 v16, s[36:39], s48 offen offset:3072 lds
    s_add_u32 m0, m0, 4096
    s_add_u32 s48, s49, 110592
    buffer_load_dwordx4 v16, s[36:39], s48 offen offset:0 lds
    s_add_u32 s48, s49, 118784
    buffer_load_dwordx4 v16, s[36:39], s48 offen offset:1024 lds
    s_add_u32 s48, s49, 126976
    buffer_load_dwordx4 v16, s[36:39], s48 offen offset:2048 lds
    s_add_u32 s48, s49, 135168
    buffer_load_dwordx4 v16, s[36:39], s48 offen offset:3072 lds
    s_add_u32 s100, s100, 128
    s_cmp_eq_u32 s100, 1152
    s_cselect_b32 s100, 0, s100
    s_add_u32 s91, s91, 35840
    s_cmp_eq_u32 s91, 143360
    s_cselect_b32 s91, 0, s91
    s_barrier
    s_barrier
    s_mov_b32 s55, 0
Lwp_10:
    s_waitcnt vmcnt(16)
    s_barrier
    s_add_u32 s49, s53, s100
    s_add_u32 m0, s66, s91
    s_add_u32 s48, s49, 0
    buffer_load_dwordx4 v16, s[36:39], s48 offen offset:0 lds
    s_add_u32 s48, s49, 8192
    buffer_load_dwordx4 v16, s[36:39], s48 offen offset:1024 lds
    s_add_u32 s48, s49, 16384
    buffer_load_dwordx4 v16, s[36:39], s48 offen offset:2048 lds
    s_add_u32 s48, s49, 24576
    buffer_load_dwordx4 v16, s[36:39], s48 offen offset:3072 lds
    s_add_u32 m0, m0, 4096
    s_add_u32 s48, s49, 36864
    buffer_load_dwordx4 v16, s[36:39], s48 offen offset:0 lds
    s_add_u32 s48, s49, 45056
    buffer_load_dwordx4 v16, s[36:39], s48 offen offset:1024 lds
    s_add_u32 s48, s49, 53248
    buffer_load_dwordx4 v16, s[36:39], s48 offen offset:2048 lds
    s_add_u32 s48, s49, 61440
    buffer_load_dwordx4 v16, s[36:39], s48 offen offset:3072 lds
    s_add_u32 m0, m0, 4096
    s_add_u32 s48, s49, 73728
    buffer_load_dwordx4 v16, s[36:39], s48 offen offset:0 lds
    s_add_u32 s48, s49, 81920
    buffer_load_dwordx4 v16, s[36:39], s48 offen offset:1024 lds
    s_add_u32 s48, s49, 90112
    buffer_load_dwordx4 v16, s[36:39], s48 offen offset:2048 lds
    s_add_u32 s48, s49, 98304
    buffer_load_dwordx4 v16, s[36:39], s48 offen offset:3072 lds
    s_add_u32 m0, m0, 4096
    s_add_u32 s48, s49, 110592
    buffer_load_dwordx4 v16, s[36:39], s48 offen offset:0 lds
    s_add_u32 s48, s49, 118784
    buffer_load_dwordx4 v16, s[36:39], s48 offen offset:1024 lds
    s_add_u32 s48, s49, 126976
    buffer_load_dwordx4 v16, s[36:39], s48 offen offset:2048 lds
    s_add_u32 s48, s49, 135168
    buffer_load_dwordx4 v16, s[36:39], s48 offen offset:3072 lds
    s_add_u32 s100, s100, 128
    s_cmp_eq_u32 s100, 1152
    s_cselect_b32 s100, 0, s100
    s_add_u32 s91, s91, 35840
    s_cmp_eq_u32 s91, 143360
    s_cselect_b32 s91, 0, s91
    s_add_u32 s55, s55, 1
    s_cmp_lt_u32 s55, 6
    s_cbranch_scc1 Lwp_10
    s_waitcnt vmcnt(0)
    s_barrier
    s_barrier
    s_barrier
    s_barrier
    s_add_u32 s55, s47, 4
    s_branch L_reduce
L_notw:
    s_cmp_ge_u32 s44, 4
    s_cbranch_scc1 L_kvloader
    s_waitcnt lgkmcnt(0)
    s_lshl_b32 s48, s45, 4
    s_add_u32 s48, s48, s46
    s_mul_i32 s49, s45, 110592
    s_add_u32 s12, s14, s49
    s_addc_u32 s13, s15, 0
    s_mov_b32 s14, 110592
    s_mov_b32 s15, 0x20000
    s_mul_i32 s49, s45, 1769472
    s_add_u32 s49, s49, 1048576
    s_add_u32 s4, s18, s49
    s_addc_u32 s5, s19, 0
    s_mov_b32 s6, 1769472
    s_mov_b32 s7, 0x20000
    s_mul_i32 s49, s45, 1152
    s_add_u32 s49, s49, 524288
    s_add_u32 s8, s18, s49
    s_addc_u32 s9, s19, 0
    s_mov_b32 s10, 1152
    s_mov_b32 s11, 0x20000
    v_and_b32 v255, 63, v0
    s_lshr_b32 s64, s44, 1
    s_and_b32 s65, s44, 1
    v_lshrrev_b32 v240, 4, v255
    v_bfe_u32 v241, v255, 2, 2
    v_and_b32 v242, 3, v255
    v_and_b32 v243, 15, v255
    v_lshlrev_b32 v252, 3, v240
    v_add_u32 v252, v252, v241
    v_lshlrev_b32 v252, 9, v252
    v_and_b32 v253, 1, v240
    v_lshlrev_b32 v253, 2, v253
    v_add_u32 v253, v253, v241
    v_lshlrev_b32 v253, 5, v253
    v_add_u32 v252, v252, v253
    v_lshlrev_b32 v253, 3, v242
    v_add_u32 v252, v252, v253
    s_lshl_b32 s48, s64, 8
    s_add_u32 s48, s48, 71680
    v_add_u32 v252, s48, v252
    v_xor_b32 v232, 0, v252
    v_xor_b32 v233, 32, v252
    v_xor_b32 v234, 64, v252
    v_xor_b32 v235, 96, v252
    v_xor_b32 v236, 128, v252
    v_xor_b32 v237, 160, v252
    v_xor_b32 v238, 192, v252
    v_xor_b32 v239, 224, v252
    s_mul_i32 s48, s65, 6144
    s_add_u32 s48, s48, 137216
    v_lshrrev_b32 v252, 1, v243
    v_xor_b32 v252, v252, v240
    v_lshlrev_b32 v252, 4, v252
    v_lshlrev_b32 v253, 7, v243
    v_add_u32 v252, v252, v253
    v_add_u32 v244, s48, v252
    v_xor_b32 v245, 64, v244
    v_lshrrev_b32 v252, 2, v243
    v_mul_u32_u24 v252, 1088, v252
    v_and_b32 v253, 3, v243
    v_lshlrev_b32 v247, 8, v253
    v_add_u32 v252, v252, v247
    v_xor_b32 v253, v253, v240
    v_lshlrev_b32 v253, 4, v253
    v_add_u32 v247, v252, v253
    v_mul_u32_u24 v252, 1152, v240
    v_lshlrev_b32 v253, 8, v241
    v_add_u32 v252, v252, v253
    v_lshlrev_b32 v253, 3, v242
    v_add_u32 v252, v252, v253
    v_add_u32 v252, 17408, v252
    v_xor_b32 v253, 0, v241
    v_lshlrev_b32 v253, 5, v253
    v_add_u32 v248, v252, v253
    v_xor_b32 v253, 1, v241
    v_lshlrev_b32 v253, 5, v253
    v_add_u32 v249, v252, v253
    v_xor_b32 v253, 2, v241
    v_lshlrev_b32 v253, 5, v253
    v_add_u32 v250, v252, v253
    v_xor_b32 v253, 3, v241
    v_lshlrev_b32 v253, 5, v253
    v_add_u32 v251, v252, v253
    v_mov_b64 v[0:1], 0
    v_mov_b64 v[2:3], 0
    v_mov_b64 v[4:5], 0
    v_mov_b64 v[6:7], 0
    v_mov_b64 v[8:9], 0
    v_mov_b64 v[10:11], 0
    v_mov_b64 v[12:13], 0
    v_mov_b64 v[14:15], 0
    v_mov_b64 v[16:17], 0
    v_mov_b64 v[18:19], 0
    v_mov_b64 v[20:21], 0
    v_mov_b64 v[22:23], 0
    v_mov_b64 v[24:25], 0
    v_mov_b64 v[26:27], 0
    v_mov_b64 v[28:29], 0
    v_mov_b64 v[30:31], 0
    v_mov_b64 v[32:33], 0
    v_mov_b64 v[34:35], 0
    v_mov_b64 v[36:37], 0
    v_mov_b64 v[38:39], 0
    v_mov_b64 v[40:41], 0
    v_mov_b64 v[42:43], 0
    v_mov_b64 v[44:45], 0
    v_mov_b64 v[46:47], 0
    v_mov_b64 v[48:49], 0
    v_mov_b64 v[50:51], 0
    v_mov_b64 v[52:53], 0
    v_mov_b64 v[54:55], 0
    v_mov_b64 v[56:57], 0
    v_mov_b64 v[58:59], 0
    v_mov_b64 v[60:61], 0
    v_mov_b64 v[62:63], 0
    v_mov_b64 v[64:65], 0
    v_mov_b64 v[66:67], 0
    v_mov_b64 v[68:69], 0
    v_mov_b64 v[70:71], 0
    v_mov_b64 v[72:73], 0
    v_mov_b64 v[74:75], 0
    v_mov_b64 v[76:77], 0
    v_mov_b64 v[78:79], 0
    v_mov_b64 v[80:81], 0
    v_mov_b64 v[82:83], 0
    v_mov_b64 v[84:85], 0
    v_mov_b64 v[86:87], 0
    v_mov_b64 v[88:89], 0
    v_mov_b64 v[90:91], 0
    v_mov_b64 v[92:93], 0
    v_mov_b64 v[94:95], 0
    s_barrier
    ds_read_b128 v[208:211], v244 offset:0
    ds_read_b128 v[212:215], v244 offset:2048
    ds_read_b128 v[216:219], v244 offset:4096
    ds_read_b64_tr_b16 v[144:145], v232 offset:32768
    ds_read_b64_tr_b16 v[146:147], v232 offset:34816
    ds_read_b64_tr_b16 v[148:149], v233 offset:32768
    ds_read_b64_tr_b16 v[150:151], v233 offset:34816
    ds_read_b64_tr_b16 v[152:153], v234 offset:32768
    ds_read_b64_tr_b16 v[154:155], v234 offset:34816
    ds_read_b64_tr_b16 v[156:157], v235 offset:32768
    ds_read_b64_tr_b16 v[158:159], v235 offset:34816
    ds_read_b64_tr_b16 v[160:161], v236 offset:32768
    ds_read_b64_tr_b16 v[162:163], v236 offset:34816
    ds_read_b64_tr_b16 v[164:165], v237 offset:32768
    ds_read_b64_tr_b16 v[166:167], v237 offset:34816
    ds_read_b64_tr_b16 v[168:169], v238 offset:32768
    ds_read_b64_tr_b16 v[170:171], v238 offset:34816
    ds_read_b64_tr_b16 v[172:173], v239 offset:32768
    ds_read_b64_tr_b16 v[174:175], v239 offset:34816
    s_mov_b32 s55, 0
Lq_11:
    s_waitcnt lgkmcnt(0)
    s_barrier
    v_mfma_f32_16x16x32_bf16 v[0:3], v[144:147], v[208:211], v[0:3]
    ds_read_b128 v[220:223], v245 offset:0
    ds_read_b128 v[224:227], v245 offset:2048
    v_mfma_f32_16x16x32_bf16 v[32:35], v[144:147], v[212:215], v[32:35]
    ds_read_b128 v[228:231], v245 offset:4096
    v_mfma_f32_16x16x32_bf16 v[64:67], v[144:147], v[216:219], v[64:67]
    ds_read_b64_tr_b16 v[176:177], v232 offset:49152
    v_mfma_f32_16x16x32_bf16 v[4:7], v[148:151], v[208:211], v[4:7]
    ds_read_b64_tr_b16 v[178:179], v232 offset:51200
    v_mfma_f32_16x16x32_bf16 v[36:39], v[148:151], v[212:215], v[36:39]
    ds_read_b64_tr_b16 v[180:181], v233 offset:49152
    v_mfma_f32_16x16x32_bf16 v[68:71], v[148:151], v[216:219], v[68:71]
    ds_read_b64_tr_b16 v[182:183], v233 offset:51200
    v_mfma_f32_16x16x32_bf16 v[8:11], v[152:155], v[208:211], v[8:11]
    ds_read_b64_tr_b16 v[184:185], v234 offset:49152
    v_mfma_f32_16x16x32_bf16 v[40:43], v[152:155], v[212:215], v[40:43]
    ds_read_b64_tr_b16 v[186:187], v234 offset:51200
    v_mfma_f32_16x16x32_bf16 v[72:75], v[152:155], v[216:219], v[72:75]
    ds_read_b64_tr_b16 v[188:189], v235 offset:49152
    ds_read_b64_tr_b16 v[190:191], v235 offset:51200
    v_mfma_f32_16x16x32_bf16 v[12:15], v[156:159], v[208:211], v[12:15]
    ds_read_b64_tr_b16 v[192:193], v236 offset:49152
    v_mfma_f32_16x16x32_bf16 v[44:47], v[156:159], v[212:215], v[44:47]
    ds_read_b64_tr_b16 v[194:195], v236 offset:51200
    v_mfma_f32_16x16x32_bf16 v[76:79], v[156:159], v[216:219], v[76:79]
    ds_read_b64_tr_b16 v[196:197], v237 offset:49152
    v_mfma_f32_16x16x32_bf16 v[16:19], v[160:163], v[208:211], v[16:19]
    ds_read_b64_tr_b16 v[198:199], v237 offset:51200
    v_mfma_f32_16x16x32_bf16 v[48:51], v[160:163], v[212:215], v[48:51]
    ds_read_b64_tr_b16 v[200:201], v238 offset:49152
    v_mfma_f32_16x16x32_bf16 v[80:83], v[160:163], v[216:219], v[80:83]
    ds_read_b64_tr_b16 v[202:203], v238 offset:51200
    v_mfma_f32_16x16x32_bf16 v[20:23], v[164:167], v[208:211], v[20:23]
    ds_read_b64_tr_b16 v[204:205], v239 offset:49152
    v_mfma_f32_16x16x32_bf16 v[52:55], v[164:167], v[212:215], v[52:55]
    ds_read_b64_tr_b16 v[206:207], v239 offset:51200
    v_mfma_f32_16x16x32_bf16 v[84:87], v[164:167], v[216:219], v[84:87]
    v_mfma_f32_16x16x32_bf16 v[24:27], v[168:171], v[208:211], v[24:27]
    v_mfma_f32_16x16x32_bf16 v[56:59], v[168:171], v[212:215], v[56:59]
    v_mfma_f32_16x16x32_bf16 v[88:91], v[168:171], v[216:219], v[88:91]
    v_mfma_f32_16x16x32_bf16 v[28:31], v[172:175], v[208:211], v[28:31]
    v_mfma_f32_16x16x32_bf16 v[60:63], v[172:175], v[212:215], v[60:63]
    v_mfma_f32_16x16x32_bf16 v[92:95], v[172:175], v[216:219], v[92:95]
    s_waitcnt lgkmcnt(0)
    s_barrier
    v_mfma_f32_16x16x32_bf16 v[0:3], v[176:179], v[220:223], v[0:3]
    ds_read_b128 v[208:211], v244 offset:12288
    ds_read_b128 v[212:215], v244 offset:14336
    v_mfma_f32_16x16x32_bf16 v[32:35], v[176:179], v[224:227], v[32:35]
    ds_read_b128 v[216:219], v244 offset:16384
    v_mfma_f32_16x16x32_bf16 v[64:67], v[176:179], v[228:231], v[64:67]
    ds_read_b64_tr_b16 v[144:145], v232 offset:0
    v_mfma_f32_16x16x32_bf16 v[4:7], v[180:183], v[220:223], v[4:7]
    ds_read_b64_tr_b16 v[146:147], v232 offset:2048
    v_mfma_f32_16x16x32_bf16 v[36:39], v[180:183], v[224:227], v[36:39]
    ds_read_b64_tr_b16 v[148:149], v233 offset:0
    v_mfma_f32_16x16x32_bf16 v[68:71], v[180:183], v[228:231], v[68:71]
    ds_read_b64_tr_b16 v[150:151], v233 offset:2048
    v_mfma_f32_16x16x32_bf16 v[8:11], v[184:187], v[220:223], v[8:11]
    ds_read_b64_tr_b16 v[152:153], v234 offset:0
    v_mfma_f32_16x16x32_bf16 v[40:43], v[184:187], v[224:227], v[40:43]
    ds_read_b64_tr_b16 v[154:155], v234 offset:2048
    v_mfma_f32_16x16x32_bf16 v[72:75], v[184:187], v[228:231], v[72:75]
    ds_read_b64_tr_b16 v[156:157], v235 offset:0
    ds_read_b64_tr_b16 v[158:159], v235 offset:2048
    v_mfma_f32_16x16x32_bf16 v[12:15], v[188:191], v[220:223], v[12:15]
    ds_read_b64_tr_b16 v[160:161], v236 offset:0
    v_mfma_f32_16x16x32_bf16 v[44:47], v[188:191], v[224:227], v[44:47]
    ds_read_b64_tr_b16 v[162:163], v236 offset:2048
    v_mfma_f32_16x16x32_bf16 v[76:79], v[188:191], v[228:231], v[76:79]
    ds_read_b64_tr_b16 v[164:165], v237 offset:0
    v_mfma_f32_16x16x32_bf16 v[16:19], v[192:195], v[220:223], v[16:19]
    ds_read_b64_tr_b16 v[166:167], v237 offset:2048
    v_mfma_f32_16x16x32_bf16 v[48:51], v[192:195], v[224:227], v[48:51]
    ds_read_b64_tr_b16 v[168:169], v238 offset:0
    v_mfma_f32_16x16x32_bf16 v[80:83], v[192:195], v[228:231], v[80:83]
    ds_read_b64_tr_b16 v[170:171], v238 offset:2048
    v_mfma_f32_16x16x32_bf16 v[20:23], v[196:199], v[220:223], v[20:23]
    ds_read_b64_tr_b16 v[172:173], v239 offset:0
    v_mfma_f32_16x16x32_bf16 v[52:55], v[196:199], v[224:227], v[52:55]
    ds_read_b64_tr_b16 v[174:175], v239 offset:2048
    v_mfma_f32_16x16x32_bf16 v[84:87], v[196:199], v[228:231], v[84:87]
    v_mfma_f32_16x16x32_bf16 v[24:27], v[200:203], v[220:223], v[24:27]
    v_mfma_f32_16x16x32_bf16 v[56:59], v[200:203], v[224:227], v[56:59]
    v_mfma_f32_16x16x32_bf16 v[88:91], v[200:203], v[228:231], v[88:91]
    v_mfma_f32_16x16x32_bf16 v[28:31], v[204:207], v[220:223], v[28:31]
    v_mfma_f32_16x16x32_bf16 v[60:63], v[204:207], v[224:227], v[60:63]
    v_mfma_f32_16x16x32_bf16 v[92:95], v[204:207], v[228:231], v[92:95]
    s_waitcnt lgkmcnt(0)
    s_barrier
    v_mfma_f32_16x16x32_bf16 v[0:3], v[144:147], v[208:211], v[0:3]
    ds_read_b128 v[220:223], v245 offset:12288
    ds_read_b128 v[224:227], v245 offset:14336
    v_mfma_f32_16x16x32_bf16 v[32:35], v[144:147], v[212:215], v[32:35]
    ds_read_b128 v[228:231], v245 offset:16384
    v_mfma_f32_16x16x32_bf16 v[64:67], v[144:147], v[216:219], v[64:67]
    ds_read_b64_tr_b16 v[176:177], v232 offset:16384
    v_mfma_f32_16x16x32_bf16 v[4:7], v[148:151], v[208:211], v[4:7]
    ds_read_b64_tr_b16 v[178:179], v232 offset:18432
    v_mfma_f32_16x16x32_bf16 v[36:39], v[148:151], v[212:215], v[36:39]
    ds_read_b64_tr_b16 v[180:181], v233 offset:16384
    v_mfma_f32_16x16x32_bf16 v[68:71], v[148:151], v[216:219], v[68:71]
    ds_read_b64_tr_b16 v[182:183], v233 offset:18432
    v_mfma_f32_16x16x32_bf16 v[8:11], v[152:155], v[208:211], v[8:11]
    ds_read_b64_tr_b16 v[184:185], v234 offset:16384
    v_mfma_f32_16x16x32_bf16 v[40:43], v[152:155], v[212:215], v[40:43]
    ds_read_b64_tr_b16 v[186:187], v234 offset:18432
    v_mfma_f32_16x16x32_bf16 v[72:75], v[152:155], v[216:219], v[72:75]
    ds_read_b64_tr_b16 v[188:189], v235 offset:16384
    ds_read_b64_tr_b16 v[190:191], v235 offset:18432
    v_mfma_f32_16x16x32_bf16 v[12:15], v[156:159], v[208:211], v[12:15]
    ds_read_b64_tr_b16 v[192:193], v236 offset:16384
    v_mfma_f32_16x16x32_bf16 v[44:47], v[156:159], v[212:215], v[44:47]
    ds_read_b64_tr_b16 v[194:195], v236 offset:18432
    v_mfma_f32_16x16x32_bf16 v[76:79], v[156:159], v[216:219], v[76:79]
    ds_read_b64_tr_b16 v[196:197], v237 offset:16384
    v_mfma_f32_16x16x32_bf16 v[16:19], v[160:163], v[208:211], v[16:19]
    ds_read_b64_tr_b16 v[198:199], v237 offset:18432
    v_mfma_f32_16x16x32_bf16 v[48:51], v[160:163], v[212:215], v[48:51]
    ds_read_b64_tr_b16 v[200:201], v238 offset:16384
    v_mfma_f32_16x16x32_bf16 v[80:83], v[160:163], v[216:219], v[80:83]
    ds_read_b64_tr_b16 v[202:203], v238 offset:18432
    v_mfma_f32_16x16x32_bf16 v[20:23], v[164:167], v[208:211], v[20:23]
    ds_read_b64_tr_b16 v[204:205], v239 offset:16384
    v_mfma_f32_16x16x32_bf16 v[52:55], v[164:167], v[212:215], v[52:55]
    ds_read_b64_tr_b16 v[206:207], v239 offset:18432
    v_mfma_f32_16x16x32_bf16 v[84:87], v[164:167], v[216:219], v[84:87]
    v_mfma_f32_16x16x32_bf16 v[24:27], v[168:171], v[208:211], v[24:27]
    v_mfma_f32_16x16x32_bf16 v[56:59], v[168:171], v[212:215], v[56:59]
    v_mfma_f32_16x16x32_bf16 v[88:91], v[168:171], v[216:219], v[88:91]
    v_mfma_f32_16x16x32_bf16 v[28:31], v[172:175], v[208:211], v[28:31]
    v_mfma_f32_16x16x32_bf16 v[60:63], v[172:175], v[212:215], v[60:63]
    v_mfma_f32_16x16x32_bf16 v[92:95], v[172:175], v[216:219], v[92:95]
    s_waitcnt lgkmcnt(0)
    s_barrier
    v_mfma_f32_16x16x32_bf16 v[0:3], v[176:179], v[220:223], v[0:3]
    ds_read_b128 v[208:211], v244 offset:0
    ds_read_b128 v[212:215], v244 offset:2048
    v_mfma_f32_16x16x32_bf16 v[32:35], v[176:179], v[224:227], v[32:35]
    ds_read_b128 v[216:219], v244 offset:4096
    v_mfma_f32_16x16x32_bf16 v[64:67], v[176:179], v[228:231], v[64:67]
    ds_read_b64_tr_b16 v[144:145], v232 offset:32768
    v_mfma_f32_16x16x32_bf16 v[4:7], v[180:183], v[220:223], v[4:7]
    ds_read_b64_tr_b16 v[146:147], v232 offset:34816
    v_mfma_f32_16x16x32_bf16 v[36:39], v[180:183], v[224:227], v[36:39]
    ds_read_b64_tr_b16 v[148:149], v233 offset:32768
    v_mfma_f32_16x16x32_bf16 v[68:71], v[180:183], v[228:231], v[68:71]
    ds_read_b64_tr_b16 v[150:151], v233 offset:34816
    v_mfma_f32_16x16x32_bf16 v[8:11], v[184:187], v[220:223], v[8:11]
    ds_read_b64_tr_b16 v[152:153], v234 offset:32768
    v_mfma_f32_16x16x32_bf16 v[40:43], v[184:187], v[224:227], v[40:43]
    ds_read_b64_tr_b16 v[154:155], v234 offset:34816
    v_mfma_f32_16x16x32_bf16 v[72:75], v[184:187], v[228:231], v[72:75]
    ds_read_b64_tr_b16 v[156:157], v235 offset:32768
    ds_read_b64_tr_b16 v[158:159], v235 offset:34816
    v_mfma_f32_16x16x32_bf16 v[12:15], v[188:191], v[220:223], v[12:15]
    ds_read_b64_tr_b16 v[160:161], v236 offset:32768
    v_mfma_f32_16x16x32_bf16 v[44:47], v[188:191], v[224:227], v[44:47]
    ds_read_b64_tr_b16 v[162:163], v236 offset:34816
    v_mfma_f32_16x16x32_bf16 v[76:79], v[188:191], v[228:231], v[76:79]
    ds_read_b64_tr_b16 v[164:165], v237 offset:32768
    v_mfma_f32_16x16x32_bf16 v[16:19], v[192:195], v[220:223], v[16:19]
    ds_read_b64_tr_b16 v[166:167], v237 offset:34816
    v_mfma_f32_16x16x32_bf16 v[48:51], v[192:195], v[224:227], v[48:51]
    ds_read_b64_tr_b16 v[168:169], v238 offset:32768
    v_mfma_f32_16x16x32_bf16 v[80:83], v[192:195], v[228:231], v[80:83]
    ds_read_b64_tr_b16 v[170:171], v238 offset:34816
    v_mfma_f32_16x16x32_bf16 v[20:23], v[196:199], v[220:223], v[20:23]
    ds_read_b64_tr_b16 v[172:173], v239 offset:32768
    v_mfma_f32_16x16x32_bf16 v[52:55], v[196:199], v[224:227], v[52:55]
    ds_read_b64_tr_b16 v[174:175], v239 offset:34816
    v_mfma_f32_16x16x32_bf16 v[84:87], v[196:199], v[228:231], v[84:87]
    v_mfma_f32_16x16x32_bf16 v[24:27], v[200:203], v[220:223], v[24:27]
    v_mfma_f32_16x16x32_bf16 v[56:59], v[200:203], v[224:227], v[56:59]
    v_mfma_f32_16x16x32_bf16 v[88:91], v[200:203], v[228:231], v[88:91]
    v_mfma_f32_16x16x32_bf16 v[28:31], v[204:207], v[220:223], v[28:31]
    v_mfma_f32_16x16x32_bf16 v[60:63], v[204:207], v[224:227], v[60:63]
    v_mfma_f32_16x16x32_bf16 v[92:95], v[204:207], v[228:231], v[92:95]
    s_add_u32 s55, s55, 1
    s_cmp_lt_u32 s55, 4
    s_cbranch_scc1 Lq_11
    s_waitcnt lgkmcnt(0)
    s_barrier
    v_mfma_f32_16x16x32_bf16 v[0:3], v[144:147], v[208:211], v[0:3]
    ds_read_b128 v[220:223], v245 offset:0
    ds_read_b128 v[224:227], v245 offset:2048
    v_mfma_f32_16x16x32_bf16 v[32:35], v[144:147], v[212:215], v[32:35]
    ds_read_b128 v[228:231], v245 offset:4096
    v_mfma_f32_16x16x32_bf16 v[64:67], v[144:147], v[216:219], v[64:67]
    ds_read_b64_tr_b16 v[176:177], v232 offset:49152
    v_mfma_f32_16x16x32_bf16 v[4:7], v[148:151], v[208:211], v[4:7]
    ds_read_b64_tr_b16 v[178:179], v232 offset:51200
    v_mfma_f32_16x16x32_bf16 v[36:39], v[148:151], v[212:215], v[36:39]
    ds_read_b64_tr_b16 v[180:181], v233 offset:49152
    v_mfma_f32_16x16x32_bf16 v[68:71], v[148:151], v[216:219], v[68:71]
    ds_read_b64_tr_b16 v[182:183], v233 offset:51200
    v_mfma_f32_16x16x32_bf16 v[8:11], v[152:155], v[208:211], v[8:11]
    ds_read_b64_tr_b16 v[184:185], v234 offset:49152
    v_mfma_f32_16x16x32_bf16 v[40:43], v[152:155], v[212:215], v[40:43]
    ds_read_b64_tr_b16 v[186:187], v234 offset:51200
    v_mfma_f32_16x16x32_bf16 v[72:75], v[152:155], v[216:219], v[72:75]
    ds_read_b64_tr_b16 v[188:189], v235 offset:49152
    ds_read_b64_tr_b16 v[190:191], v235 offset:51200
    v_mfma_f32_16x16x32_bf16 v[12:15], v[156:159], v[208:211], v[12:15]
    ds_read_b64_tr_b16 v[192:193], v236 offset:49152
    v_mfma_f32_16x16x32_bf16 v[44:47], v[156:159], v[212:215], v[44:47]
    ds_read_b64_tr_b16 v[194:195], v236 offset:51200
    v_mfma_f32_16x16x32_bf16 v[76:79], v[156:159], v[216:219], v[76:79]
    ds_read_b64_tr_b16 v[196:197], v237 offset:49152
    v_mfma_f32_16x16x32_bf16 v[16:19], v[160:163], v[208:211], v[16:19]
    ds_read_b64_tr_b16 v[198:199], v237 offset:51200
    v_mfma_f32_16x16x32_bf16 v[48:51], v[160:163], v[212:215], v[48:51]
    ds_read_b64_tr_b16 v[200:201], v238 offset:49152
    v_mfma_f32_16x16x32_bf16 v[80:83], v[160:163], v[216:219], v[80:83]
    ds_read_b64_tr_b16 v[202:203], v238 offset:51200
    v_mfma_f32_16x16x32_bf16 v[20:23], v[164:167], v[208:211], v[20:23]
    ds_read_b64_tr_b16 v[204:205], v239 offset:49152
    v_mfma_f32_16x16x32_bf16 v[52:55], v[164:167], v[212:215], v[52:55]
    ds_read_b64_tr_b16 v[206:207], v239 offset:51200
    v_mfma_f32_16x16x32_bf16 v[84:87], v[164:167], v[216:219], v[84:87]
    v_mfma_f32_16x16x32_bf16 v[24:27], v[168:171], v[208:211], v[24:27]
    v_mfma_f32_16x16x32_bf16 v[56:59], v[168:171], v[212:215], v[56:59]
    v_mfma_f32_16x16x32_bf16 v[88:91], v[168:171], v[216:219], v[88:91]
    v_mfma_f32_16x16x32_bf16 v[28:31], v[172:175], v[208:211], v[28:31]
    v_mfma_f32_16x16x32_bf16 v[60:63], v[172:175], v[212:215], v[60:63]
    v_mfma_f32_16x16x32_bf16 v[92:95], v[172:175], v[216:219], v[92:95]
    s_waitcnt lgkmcnt(0)
    s_barrier
    v_mfma_f32_16x16x32_bf16 v[0:3], v[176:179], v[220:223], v[0:3]
    v_mfma_f32_16x16x32_bf16 v[32:35], v[176:179], v[224:227], v[32:35]
    v_mfma_f32_16x16x32_bf16 v[64:67], v[176:179], v[228:231], v[64:67]
    v_mfma_f32_16x16x32_bf16 v[4:7], v[180:183], v[220:223], v[4:7]
    v_mfma_f32_16x16x32_bf16 v[36:39], v[180:183], v[224:227], v[36:39]
    v_mfma_f32_16x16x32_bf16 v[68:71], v[180:183], v[228:231], v[68:71]
    v_mfma_f32_16x16x32_bf16 v[8:11], v[184:187], v[220:223], v[8:11]
    v_mfma_f32_16x16x32_bf16 v[40:43], v[184:187], v[224:227], v[40:43]
    v_mfma_f32_16x16x32_bf16 v[72:75], v[184:187], v[228:231], v[72:75]
    v_mfma_f32_16x16x32_bf16 v[12:15], v[188:191], v[220:223], v[12:15]
    v_mfma_f32_16x16x32_bf16 v[44:47], v[188:191], v[224:227], v[44:47]
    v_mfma_f32_16x16x32_bf16 v[76:79], v[188:191], v[228:231], v[76:79]
    v_mfma_f32_16x16x32_bf16 v[16:19], v[192:195], v[220:223], v[16:19]
    v_mfma_f32_16x16x32_bf16 v[48:51], v[192:195], v[224:227], v[48:51]
    v_mfma_f32_16x16x32_bf16 v[80:83], v[192:195], v[228:231], v[80:83]
    v_mfma_f32_16x16x32_bf16 v[20:23], v[196:199], v[220:223], v[20:23]
    v_mfma_f32_16x16x32_bf16 v[52:55], v[196:199], v[224:227], v[52:55]
    v_mfma_f32_16x16x32_bf16 v[84:87], v[196:199], v[228:231], v[84:87]
    v_mfma_f32_16x16x32_bf16 v[24:27], v[200:203], v[220:223], v[24:27]
    v_mfma_f32_16x16x32_bf16 v[56:59], v[200:203], v[224:227], v[56:59]
    v_mfma_f32_16x16x32_bf16 v[88:91], v[200:203], v[228:231], v[88:91]
    v_mfma_f32_16x16x32_bf16 v[28:31], v[204:207], v[220:223], v[28:31]
    v_mfma_f32_16x16x32_bf16 v[60:63], v[204:207], v[224:227], v[60:63]
    v_mfma_f32_16x16x32_bf16 v[92:95], v[204:207], v[228:231], v[92:95]
    s_mov_b32 s48, 0x3e0293ee
    s_mov_b32 s49, s48
    v_mov_b64 v[232:233], 0
    v_mov_b64 v[234:235], 0
    s_nop 4
    v_pk_mul_f32 v[0:1], v[0:1], s[48:49]
    v_pk_mul_f32 v[2:3], v[2:3], s[48:49]
    v_pk_mul_f32 v[4:5], v[4:5], s[48:49]
    v_pk_mul_f32 v[6:7], v[6:7], s[48:49]
    v_pk_mul_f32 v[32:33], v[32:33], s[48:49]
    v_pk_mul_f32 v[34:35], v[34:35], s[48:49]
    v_pk_mul_f32 v[36:37], v[36:37], s[48:49]
    v_pk_mul_f32 v[38:39], v[38:39], s[48:49]
    v_cvt_pk_bf16_f32 v96, v0, v1
    v_cvt_pk_bf16_f32 v97, v2, v3
    v_cvt_pk_bf16_f32 v98, v4, v5
    v_cvt_pk_bf16_f32 v99, v6, v7
    v_cvt_pk_bf16_f32 v112, v32, v33
    v_cvt_pk_bf16_f32 v113, v34, v35
    v_cvt_pk_bf16_f32 v114, v36, v37
    v_cvt_pk_bf16_f32 v115, v38, v39
    v_mov_b64 v[0:1], 0
    v_mov_b64 v[2:3], 0
    v_permlane32_swap_b32 v96, v98
    v_permlane32_swap_b32 v97, v99
    v_permlane32_swap_b32 v112, v114
    v_permlane32_swap_b32 v113, v115
    v_mov_b64 v[4:5], 0
    v_mov_b64 v[6:7], 0
    v_permlane16_swap_b32 v96, v98
    v_permlane16_swap_b32 v97, v99
    v_mov_b64 v[32:33], 0
    v_mov_b64 v[34:35], 0
    v_permlane16_swap_b32 v112, v114
    v_permlane16_swap_b32 v113, v115
    v_mov_b64 v[36:37], 0
    v_mov_b64 v[38:39], 0
    v_pk_mul_f32 v[64:65], v[64:65], s[48:49]
    v_pk_mul_f32 v[66:67], v[66:67], s[48:49]
    v_pk_mul_f32 v[68:69], v[68:69], s[48:49]
    v_pk_mul_f32 v[70:71], v[70:71], s[48:49]
    v_pk_mul_f32 v[8:9], v[8:9], s[48:49]
    v_pk_mul_f32 v[10:11], v[10:11], s[48:49]
    v_pk_mul_f32 v[12:13], v[12:13], s[48:49]
    v_pk_mul_f32 v[14:15], v[14:15], s[48:49]
    v_cvt_pk_bf16_f32 v128, v64, v65
    v_cvt_pk_bf16_f32 v129, v66, v67
    v_cvt_pk_bf16_f32 v130, v68, v69
    v_cvt_pk_bf16_f32 v131, v70, v71
    v_cvt_pk_bf16_f32 v100, v8, v9
    v_cvt_pk_bf16_f32 v101, v10, v11
    v_cvt_pk_bf16_f32 v102, v12, v13
    v_cvt_pk_bf16_f32 v103, v14, v15
    v_mov_b64 v[64:65], 0
    v_mov_b64 v[66:67], 0
    v_permlane32_swap_b32 v128, v130
    v_permlane32_swap_b32 v129, v131
    v_permlane32_swap_b32 v100, v102
    v_permlane32_swap_b32 v101, v103
    v_mov_b64 v[68:69], 0
    v_mov_b64 v[70:71], 0
    v_permlane16_swap_b32 v128, v130
    v_permlane16_swap_b32 v129, v131
    v_mov_b64 v[8:9], 0
    v_mov_b64 v[10:11], 0
    v_permlane16_swap_b32 v100, v102
    v_permlane16_swap_b32 v101, v103
    v_mov_b64 v[12:13], 0
    v_mov_b64 v[14:15], 0
    v_pk_mul_f32 v[40:41], v[40:41], s[48:49]
    v_pk_mul_f32 v[42:43], v[42:43], s[48:49]
    v_pk_mul_f32 v[44:45], v[44:45], s[48:49]
    v_pk_mul_f32 v[46:47], v[46:47], s[48:49]
    v_pk_mul_f32 v[72:73], v[72:73], s[48:49]
    v_pk_mul_f32 v[74:75], v[74:75], s[48:49]
    v_pk_mul_f32 v[76:77], v[76:77], s[48:49]
    v_pk_mul_f32 v[78:79], v[78:79], s[48:49]
    v_cvt_pk_bf16_f32 v116, v40, v41
    v_cvt_pk_bf16_f32 v117, v42, v43
    v_cvt_pk_bf16_f32 v118, v44, v45
    v_cvt_pk_bf16_f32 v119, v46, v47
    v_cvt_pk_bf16_f32 v132, v72, v73
    v_cvt_pk_bf16_f32 v133, v74, v75
    v_cvt_pk_bf16_f32 v134, v76, v77
    v_cvt_pk_bf16_f32 v135, v78, v79
    v_mov_b64 v[40:41], 0
    v_mov_b64 v[42:43], 0
    v_permlane32_swap_b32 v116, v118
    v_permlane32_swap_b32 v117, v119
    v_permlane32_swap_b32 v132, v134
    v_permlane32_swap_b32 v133, v135
    v_mov_b64 v[44:45], 0
    v_mov_b64 v[46:47], 0
    v_permlane16_swap_b32 v116, v118
    v_permlane16_swap_b32 v117, v119
    v_mov_b64 v[72:73], 0
    v_mov_b64 v[74:75], 0
    v_permlane16_swap_b32 v132, v134
    v_permlane16_swap_b32 v133, v135
    v_mov_b64 v[76:77], 0
    v_mov_b64 v[78:79], 0
    v_pk_mul_f32 v[16:17], v[16:17], s[48:49]
    v_pk_mul_f32 v[18:19], v[18:19], s[48:49]
    v_pk_mul_f32 v[20:21], v[20:21], s[48:49]
    v_pk_mul_f32 v[22:23], v[22:23], s[48:49]
    v_pk_mul_f32 v[48:49], v[48:49], s[48:49]
    v_pk_mul_f32 v[50:51], v[50:51], s[48:49]
    v_pk_mul_f32 v[52:53], v[52:53], s[48:49]
    v_pk_mul_f32 v[54:55], v[54:55], s[48:49]
    v_cvt_pk_bf16_f32 v104, v16, v17
    v_cvt_pk_bf16_f32 v105, v18, v19
    v_cvt_pk_bf16_f32 v106, v20, v21
    v_cvt_pk_bf16_f32 v107, v22, v23
    v_cvt_pk_bf16_f32 v120, v48, v49
    v_cvt_pk_bf16_f32 v121, v50, v51
    v_cvt_pk_bf16_f32 v122, v52, v53
    v_cvt_pk_bf16_f32 v123, v54, v55
    v_mov_b64 v[16:17], 0
    v_mov_b64 v[18:19], 0
    v_permlane32_swap_b32 v104, v106
    v_permlane32_swap_b32 v105, v107
    v_permlane32_swap_b32 v120, v122
    v_permlane32_swap_b32 v121, v123
    v_mov_b64 v[20:21], 0
    v_mov_b64 v[22:23], 0
    v_permlane16_swap_b32 v104, v106
    v_permlane16_swap_b32 v105, v107
    v_mov_b64 v[48:49], 0
    v_mov_b64 v[50:51], 0
    v_permlane16_swap_b32 v120, v122
    v_permlane16_swap_b32 v121, v123
    v_mov_b64 v[52:53], 0
    v_mov_b64 v[54:55], 0
    v_pk_mul_f32 v[80:81], v[80:81], s[48:49]
    v_pk_mul_f32 v[82:83], v[82:83], s[48:49]
    v_pk_mul_f32 v[84:85], v[84:85], s[48:49]
    v_pk_mul_f32 v[86:87], v[86:87], s[48:49]
    v_pk_mul_f32 v[24:25], v[24:25], s[48:49]
    v_pk_mul_f32 v[26:27], v[26:27], s[48:49]
    v_pk_mul_f32 v[28:29], v[28:29], s[48:49]
    v_pk_mul_f32 v[30:31], v[30:31], s[48:49]
    v_cvt_pk_bf16_f32 v136, v80, v81
    v_cvt_pk_bf16_f32 v137, v82, v83
    v_cvt_pk_bf16_f32 v138, v84, v85
    v_cvt_pk_bf16_f32 v139, v86, v87
    v_cvt_pk_bf16_f32 v108, v24, v25
    v_cvt_pk_bf16_f32 v109, v26, v27
    v_cvt_pk_bf16_f32 v110, v28, v29
    v_cvt_pk_bf16_f32 v111, v30, v31
    v_mov_b64 v[80:81], 0
    v_mov_b64 v[82:83], 0
    v_permlane32_swap_b32 v136, v138
    v_permlane32_swap_b32 v137, v139
    v_permlane32_swap_b32 v108, v110
    v_permlane32_swap_b32 v109, v111
    v_mov_b64 v[84:85], 0
    v_mov_b64 v[86:87], 0
    v_permlane16_swap_b32 v136, v138
    v_permlane16_swap_b32 v137, v139
    v_mov_b64 v[24:25], 0
    v_mov_b64 v[26:27], 0
    v_permlane16_swap_b32 v108, v110
    v_permlane16_swap_b32 v109, v111
    v_mov_b64 v[28:29], 0
    v_mov_b64 v[30:31], 0
    v_pk_mul_f32 v[56:57], v[56:57], s[48:49]
    v_pk_mul_f32 v[58:59], v[58:59], s[48:49]
    v_pk_mul_f32 v[60:61], v[60:61], s[48:49]
    v_pk_mul_f32 v[62:63], v[62:63], s[48:49]
    v_pk_mul_f32 v[88:89], v[88:89], s[48:49]
    v_pk_mul_f32 v[90:91], v[90:91], s[48:49]
    v_pk_mul_f32 v[92:93], v[92:93], s[48:49]
    v_pk_mul_f32 v[94:95], v[94:95], s[48:49]
    v_cvt_pk_bf16_f32 v124, v56, v57
    v_cvt_pk_bf16_f32 v125, v58, v59
    v_cvt_pk_bf16_f32 v126, v60, v61
    v_cvt_pk_bf16_f32 v127, v62, v63
    v_cvt_pk_bf16_f32 v140, v88, v89
    v_cvt_pk_bf16_f32 v141, v90, v91
    v_cvt_pk_bf16_f32 v142, v92, v93
    v_cvt_pk_bf16_f32 v143, v94, v95
    v_mov_b64 v[56:57], 0
    v_mov_b64 v[58:59], 0
    v_permlane32_swap_b32 v124, v126
    v_permlane32_swap_b32 v125, v127
    v_permlane32_swap_b32 v140, v142
    v_permlane32_swap_b32 v141, v143
    v_mov_b64 v[60:61], 0
    v_mov_b64 v[62:63], 0
    v_permlane16_swap_b32 v124, v126
    v_permlane16_swap_b32 v125, v127
    v_mov_b64 v[88:89], 0
    v_mov_b64 v[90:91], 0
    v_permlane16_swap_b32 v140, v142
    v_permlane16_swap_b32 v141, v143
    v_mov_b64 v[92:93], 0
    v_mov_b64 v[94:95], 0
    s_barrier
    ds_read_b128 v[144:147], v247 offset:0
    ds_read_b128 v[160:163], v247 offset:4352
    ds_read_b128 v[148:151], v247 offset:64
    ds_read_b128 v[164:167], v247 offset:4416
    ds_read_b128 v[152:155], v247 offset:128
    ds_read_b128 v[168:171], v247 offset:4480
    ds_read_b128 v[156:159], v247 offset:192
    ds_read_b128 v[172:175], v247 offset:4544
    s_waitcnt lgkmcnt(0)
    v_mfma_f32_16x16x32_bf16 v[176:179], v[144:147], v[96:99], 0
    v_mfma_f32_16x16x32_bf16 v[180:183], v[160:163], v[96:99], 0
    v_mfma_f32_16x16x32_bf16 v[176:179], v[148:151], v[100:103], v[176:179]
    v_mfma_f32_16x16x32_bf16 v[180:183], v[164:167], v[100:103], v[180:183]
    v_mfma_f32_16x16x32_bf16 v[176:179], v[152:155], v[104:107], v[176:179]
    v_mfma_f32_16x16x32_bf16 v[180:183], v[168:171], v[104:107], v[180:183]
    v_mfma_f32_16x16x32_bf16 v[176:179], v[156:159], v[108:111], v[176:179]
    v_mfma_f32_16x16x32_bf16 v[180:183], v[172:175], v[108:111], v[180:183]
    v_mfma_f32_16x16x32_bf16 v[184:187], v[144:147], v[112:115], 0
    v_mfma_f32_16x16x32_bf16 v[188:191], v[160:163], v[112:115], 0
    v_mfma_f32_16x16x32_bf16 v[184:187], v[148:151], v[116:119], v[184:187]
    v_mfma_f32_16x16x32_bf16 v[188:191], v[164:167], v[116:119], v[188:191]
    v_mfma_f32_16x16x32_bf16 v[184:187], v[152:155], v[120:123], v[184:187]
    v_mfma_f32_16x16x32_bf16 v[188:191], v[168:171], v[120:123], v[188:191]
    v_mfma_f32_16x16x32_bf16 v[184:187], v[156:159], v[124:127], v[184:187]
    v_mfma_f32_16x16x32_bf16 v[188:191], v[172:175], v[124:127], v[188:191]
    v_mfma_f32_16x16x32_bf16 v[192:195], v[144:147], v[128:131], 0
    v_mfma_f32_16x16x32_bf16 v[196:199], v[160:163], v[128:131], 0
    v_mfma_f32_16x16x32_bf16 v[192:195], v[148:151], v[132:135], v[192:195]
    v_mfma_f32_16x16x32_bf16 v[196:199], v[164:167], v[132:135], v[196:199]
    v_mfma_f32_16x16x32_bf16 v[192:195], v[152:155], v[136:139], v[192:195]
    v_mfma_f32_16x16x32_bf16 v[196:199], v[168:171], v[136:139], v[196:199]
    v_mfma_f32_16x16x32_bf16 v[192:195], v[156:159], v[140:143], v[192:195]
    v_mfma_f32_16x16x32_bf16 v[196:199], v[172:175], v[140:143], v[196:199]
    v_mov_b64 v[224:225], 0
    v_mov_b64 v[226:227], 0
    v_mov_b64 v[228:229], 0
    v_mov_b64 v[230:231], 0
    v_mov_b32 v244, 0
    v_mov_b32 v245, 0
    v_mov_b32 v246, 0
    v_mov_b32 v254, 0
    s_mov_b32 s54, 0x43800000
    s_mov_b32 s58, 0
    s_mov_b32 s56, 0
    s_mov_b32 s57, 0xfffe5c00
    s_mov_b64 vcc, 0
    s_nop 3
    v_max3_f32 v200, v176, v177, v178
    v_max3_f32 v201, v179, v180, v181
    v_max3_f32 v200, v200, v182, v183
    v_max_f32 v200, v200, v201
    v_max3_f32 v202, v184, v185, v186
    v_max3_f32 v203, v187, v188, v189
    v_max3_f32 v202, v202, v190, v191
    v_max_f32 v202, v202, v203
    v_max3_f32 v204, v192, v193, v194
    v_max3_f32 v205, v195, v196, v197
    v_max3_f32 v204, v204, v198, v199
    v_max_f32 v204, v204, v205
    v_mov_b32 v201, v200
    v_mov_b32 v203, v202
    v_mov_b32 v205, v204
    s_nop 0
    v_permlane32_swap_b32 v200, v201
    v_permlane32_swap_b32 v202, v203
    v_permlane32_swap_b32 v204, v205
    v_max_f32 v200, v200, v201
    v_max_f32 v202, v202, v203
    v_max_f32 v204, v204, v205
    v_mov_b32 v201, v200
    v_mov_b32 v203, v202
    v_mov_b32 v205, v204
    s_nop 0
    v_permlane16_swap_b32 v200, v201
    v_permlane16_swap_b32 v202, v203
    v_permlane16_swap_b32 v204, v205
    v_max_f32 v200, v200, v201
    v_max_f32 v202, v202, v203
    v_max_f32 v204, v204, v205
    v_sub_f32 v232, 0, v200
    v_sub_f32 v233, 0, v200
    v_sub_f32 v234, 0, v200
    v_sub_f32 v235, 0, v200
    v_sub_f32 v236, 0, v202
    v_sub_f32 v237, 0, v202
    v_sub_f32 v238, 0, v202
    v_sub_f32 v239, 0, v202
    v_sub_f32 v240, 0, v204
    v_sub_f32 v241, 0, v204
    v_sub_f32 v242, 0, v204
    v_sub_f32 v243, 0, v204
    v_mov_b64 v[176:177], 0
    v_mov_b64 v[178:179], 0
    v_mov_b64 v[180:181], 0
    v_mov_b64 v[182:183], 0
    v_mov_b64 v[184:185], 0
    v_mov_b64 v[186:187], 0
    v_mov_b64 v[188:189], 0
    v_mov_b64 v[190:191], 0
    v_mov_b64 v[192:193], 0
    v_mov_b64 v[194:195], 0
    v_mov_b64 v[196:197], 0
    v_mov_b64 v[198:199], 0
    v_mov_b64 v[200:201], 0
    v_mov_b64 v[202:203], 0
    v_mov_b64 v[204:205], 0
    v_mov_b64 v[206:207], 0
    v_mfma_f32_16x16x32_bf16 v[208:211], v[144:147], v[96:99], v[232:235]
    v_mfma_f32_16x16x32_bf16 v[212:215], v[160:163], v[96:99], v[232:235]
    v_mfma_f32_16x16x32_bf16 v[208:211], v[148:151], v[100:103], v[208:211]
    v_mfma_f32_16x16x32_bf16 v[212:215], v[164:167], v[100:103], v[212:215]
    v_mfma_f32_16x16x32_bf16 v[208:211], v[152:155], v[104:107], v[208:211]
    v_mfma_f32_16x16x32_bf16 v[212:215], v[168:171], v[104:107], v[212:215]
    v_mfma_f32_16x16x32_bf16 v[208:211], v[156:159], v[108:111], v[208:211]
    v_mfma_f32_16x16x32_bf16 v[212:215], v[172:175], v[108:111], v[212:215]
    s_nop 7
    s_mov_b32 s55, 0
.p2align 6
Lramp_61:
    s_cbranch_vccnz Lrare_49
Lcont_50:
    v_mfma_f32_16x16x32_bf16 v[216:219], v[144:147], v[112:115], v[236:239]
    v_exp_f32 v208, v208
    v_mfma_f32_16x16x32_bf16 v[220:223], v[160:163], v[112:115], v[236:239]
    v_exp_f32 v209, v209
    v_mfma_f32_16x16x32_bf16 v[216:219], v[148:151], v[116:119], v[216:219]
    v_exp_f32 v210, v210
    v_mfma_f32_16x16x32_bf16 v[220:223], v[164:167], v[116:119], v[220:223]
    v_exp_f32 v211, v211
    v_add_f32 v252, v208, v209
    v_mfma_f32_16x16x32_bf16 v[216:219], v[152:155], v[120:123], v[216:219]
    v_add_f32 v253, v210, v211
    v_exp_f32 v212, v212
    v_mfma_f32_16x16x32_bf16 v[220:223], v[168:171], v[120:123], v[220:223]
    v_exp_f32 v213, v213
    v_add_f32 v252, v252, v253
    v_mfma_f32_16x16x32_bf16 v[216:219], v[156:159], v[124:127], v[216:219]
    v_add_f32 v246, v246, v254
    v_add_f32 v253, v212, v213
    v_mfma_f32_16x16x32_bf16 v[220:223], v[172:175], v[124:127], v[220:223]
    v_exp_f32 v214, v214
    v_exp_f32 v215, v215
    v_add_f32 v252, v252, v253
    v_mfma_f32_16x16x32_bf16 v[64:67], v[176:179], v[228:231], v[64:67]
    v_add_f32 v253, v214, v215
    v_cvt_pk_bf16_f32 v224, v208, v209
    v_mfma_f32_16x16x32_bf16 v[68:71], v[180:183], v[228:231], v[68:71]
    v_add_f32 v254, v252, v253
    v_cvt_pk_bf16_f32 v225, v210, v211
    v_mfma_f32_16x16x32_bf16 v[72:75], v[184:187], v[228:231], v[72:75]
    v_cmp_lt_f32 vcc, s54, v254
    v_cvt_pk_bf16_f32 v226, v212, v213
    v_mfma_f32_16x16x32_bf16 v[76:79], v[188:191], v[228:231], v[76:79]
    v_cvt_pk_bf16_f32 v227, v214, v215
    v_mfma_f32_16x16x32_bf16 v[80:83], v[192:195], v[228:231], v[80:83]
    ds_read_b64_tr_b16 v[176:177], v248 offset:0
    ds_read_b64_tr_b16 v[178:179], v248 offset:4608
    v_mfma_f32_16x16x32_bf16 v[84:87], v[196:199], v[228:231], v[84:87]
    ds_read_b64_tr_b16 v[180:181], v249 offset:0
    ds_read_b64_tr_b16 v[182:183], v249 offset:4608
    v_mfma_f32_16x16x32_bf16 v[88:91], v[200:203], v[228:231], v[88:91]
    ds_read_b64_tr_b16 v[184:185], v250 offset:0
    ds_read_b64_tr_b16 v[186:187], v250 offset:4608
    v_mfma_f32_16x16x32_bf16 v[92:95], v[204:207], v[228:231], v[92:95]
    ds_read_b64_tr_b16 v[188:189], v251 offset:0
    ds_read_b64_tr_b16 v[190:191], v251 offset:4608
    s_cbranch_vccnz Lrare_51
Lcont_52:
    v_mfma_f32_16x16x32_bf16 v[208:211], v[144:147], v[128:131], v[240:243]
    v_exp_f32 v216, v216
    v_exp_f32 v217, v217
    v_mfma_f32_16x16x32_bf16 v[212:215], v[160:163], v[128:131], v[240:243]
    v_exp_f32 v218, v218
    v_exp_f32 v219, v219
    v_mfma_f32_16x16x32_bf16 v[208:211], v[148:151], v[132:135], v[208:211]
    v_add_f32 v252, v216, v217
    v_add_f32 v253, v218, v219
    v_mfma_f32_16x16x32_bf16 v[212:215], v[164:167], v[132:135], v[212:215]
    ds_read_b64_tr_b16 v[192:193], v248 offset:128
    ds_read_b64_tr_b16 v[194:195], v248 offset:4736
    v_mfma_f32_16x16x32_bf16 v[208:211], v[152:155], v[136:139], v[208:211]
    v_exp_f32 v220, v220
    v_exp_f32 v221, v221
    v_mfma_f32_16x16x32_bf16 v[212:215], v[168:171], v[136:139], v[212:215]
    v_add_f32 v252, v252, v253
    ds_read_b64_tr_b16 v[196:197], v249 offset:128
    ds_read_b64_tr_b16 v[198:199], v249 offset:4736
    v_mfma_f32_16x16x32_bf16 v[208:211], v[156:159], v[140:143], v[208:211]
    v_add_f32 v244, v244, v254
    v_add_f32 v253, v220, v221
    v_mfma_f32_16x16x32_bf16 v[212:215], v[172:175], v[140:143], v[212:215]
    ds_read_b64_tr_b16 v[200:201], v250 offset:128
    ds_read_b64_tr_b16 v[202:203], v250 offset:4736
    v_exp_f32 v222, v222
    v_exp_f32 v223, v223
    v_add_f32 v252, v252, v253
    s_waitcnt lgkmcnt(0)
    v_mfma_f32_16x16x32_bf16 v[0:3], v[176:179], v[224:227], v[0:3]
    ds_read_b64_tr_b16 v[204:205], v251 offset:128
    ds_read_b64_tr_b16 v[206:207], v251 offset:4736
    v_add_f32 v253, v222, v223
    s_waitcnt lgkmcnt(0)
    v_mfma_f32_16x16x32_bf16 v[4:7], v[180:183], v[224:227], v[4:7]
    ds_read_b128 v[144:147], v247 offset:8704
    v_add_f32 v254, v252, v253
    s_waitcnt lgkmcnt(0)
    v_mfma_f32_16x16x32_bf16 v[8:11], v[184:187], v[224:227], v[8:11]
    ds_read_b128 v[160:163], v247 offset:13056
    v_cmp_lt_f32 vcc, s54, v254
    s_waitcnt lgkmcnt(0)
    v_mfma_f32_16x16x32_bf16 v[12:15], v[188:191], v[224:227], v[12:15]
    ds_read_b128 v[148:151], v247 offset:8768
    s_waitcnt lgkmcnt(0)
    v_mfma_f32_16x16x32_bf16 v[16:19], v[192:195], v[224:227], v[16:19]
    ds_read_b128 v[164:167], v247 offset:13120
    s_waitcnt lgkmcnt(0)
    v_mfma_f32_16x16x32_bf16 v[20:23], v[196:199], v[224:227], v[20:23]
    ds_read_b128 v[152:155], v247 offset:8832
    ds_read_b128 v[168:171], v247 offset:13184
    s_waitcnt lgkmcnt(0)
    v_mfma_f32_16x16x32_bf16 v[24:27], v[200:203], v[224:227], v[24:27]
    v_cvt_pk_bf16_f32 v228, v216, v217
    v_cvt_pk_bf16_f32 v229, v218, v219
    v_cvt_pk_bf16_f32 v230, v220, v221
    v_cvt_pk_bf16_f32 v231, v222, v223
    s_waitcnt lgkmcnt(0)
    v_mfma_f32_16x16x32_bf16 v[28:31], v[204:207], v[224:227], v[28:31]
    s_cbranch_vccnz Lrare_53
Lcont_54:
    s_waitcnt lgkmcnt(0)
    v_mfma_f32_16x16x32_bf16 v[216:219], v[144:147], v[96:99], v[232:235]
    ds_read_b128 v[156:159], v247 offset:8896
    ds_read_b128 v[172:175], v247 offset:13248
    s_waitcnt lgkmcnt(0)
    v_mfma_f32_16x16x32_bf16 v[220:223], v[160:163], v[96:99], v[232:235]
    v_exp_f32 v208, v208
    s_waitcnt lgkmcnt(0)
    v_mfma_f32_16x16x32_bf16 v[216:219], v[148:151], v[100:103], v[216:219]
    v_exp_f32 v209, v209
    s_waitcnt lgkmcnt(0)
    v_mfma_f32_16x16x32_bf16 v[220:223], v[164:167], v[100:103], v[220:223]
    v_exp_f32 v210, v210
    v_exp_f32 v211, v211
    s_waitcnt lgkmcnt(0)
    v_mfma_f32_16x16x32_bf16 v[216:219], v[152:155], v[104:107], v[216:219]
    v_add_f32 v252, v208, v209
    v_add_f32 v253, v210, v211
    s_waitcnt lgkmcnt(0)
    v_mfma_f32_16x16x32_bf16 v[220:223], v[168:171], v[104:107], v[220:223]
    v_exp_f32 v212, v212
    v_exp_f32 v213, v213
    v_add_f32 v252, v252, v253
    s_waitcnt lgkmcnt(0)
    v_mfma_f32_16x16x32_bf16 v[216:219], v[156:159], v[108:111], v[216:219]
    v_add_f32 v245, v245, v254
    v_add_f32 v253, v212, v213
    s_waitcnt lgkmcnt(0)
    v_mfma_f32_16x16x32_bf16 v[220:223], v[172:175], v[108:111], v[220:223]
    v_exp_f32 v214, v214
    v_exp_f32 v215, v215
    v_add_f32 v252, v252, v253
    v_mfma_f32_16x16x32_bf16 v[32:35], v[176:179], v[228:231], v[32:35]
    v_add_f32 v253, v214, v215
    v_cvt_pk_bf16_f32 v224, v208, v209
    v_mfma_f32_16x16x32_bf16 v[36:39], v[180:183], v[228:231], v[36:39]
    v_add_f32 v254, v252, v253
    v_cvt_pk_bf16_f32 v225, v210, v211
    v_mfma_f32_16x16x32_bf16 v[40:43], v[184:187], v[228:231], v[40:43]
    v_cmp_lt_f32 vcc, s54, v254
    v_cvt_pk_bf16_f32 v226, v212, v213
    v_mfma_f32_16x16x32_bf16 v[44:47], v[188:191], v[228:231], v[44:47]
    v_cvt_pk_bf16_f32 v227, v214, v215
    v_mfma_f32_16x16x32_bf16 v[48:51], v[192:195], v[228:231], v[48:51]
    v_mfma_f32_16x16x32_bf16 v[52:55], v[196:199], v[228:231], v[52:55]
    v_mfma_f32_16x16x32_bf16 v[56:59], v[200:203], v[228:231], v[56:59]
    v_mfma_f32_16x16x32_bf16 v[60:63], v[204:207], v[228:231], v[60:63]
    s_cbranch_vccnz Lrare_55
Lcont_56:
    v_mfma_f32_16x16x32_bf16 v[208:211], v[144:147], v[112:115], v[236:239]
    v_exp_f32 v216, v216
    v_mfma_f32_16x16x32_bf16 v[212:215], v[160:163], v[112:115], v[236:239]
    v_exp_f32 v217, v217
    v_mfma_f32_16x16x32_bf16 v[208:211], v[148:151], v[116:119], v[208:211]
    v_exp_f32 v218, v218
    v_mfma_f32_16x16x32_bf16 v[212:215], v[164:167], v[116:119], v[212:215]
    v_exp_f32 v219, v219
    v_add_f32 v252, v216, v217
    v_mfma_f32_16x16x32_bf16 v[208:211], v[152:155], v[120:123], v[208:211]
    v_add_f32 v253, v218, v219
    v_exp_f32 v220, v220
    v_mfma_f32_16x16x32_bf16 v[212:215], v[168:171], v[120:123], v[212:215]
    v_exp_f32 v221, v221
    v_add_f32 v252, v252, v253
    v_mfma_f32_16x16x32_bf16 v[208:211], v[156:159], v[124:127], v[208:211]
    v_add_f32 v246, v246, v254
    v_add_f32 v253, v220, v221
    v_mfma_f32_16x16x32_bf16 v[212:215], v[172:175], v[124:127], v[212:215]
    v_exp_f32 v222, v222
    v_exp_f32 v223, v223
    v_add_f32 v252, v252, v253
    v_mfma_f32_16x16x32_bf16 v[64:67], v[176:179], v[224:227], v[64:67]
    v_add_f32 v253, v222, v223
    v_cvt_pk_bf16_f32 v228, v216, v217
    v_mfma_f32_16x16x32_bf16 v[68:71], v[180:183], v[224:227], v[68:71]
    v_add_f32 v254, v252, v253
    v_cvt_pk_bf16_f32 v229, v218, v219
    v_mfma_f32_16x16x32_bf16 v[72:75], v[184:187], v[224:227], v[72:75]
    v_cmp_lt_f32 vcc, s54, v254
    v_cvt_pk_bf16_f32 v230, v220, v221
    v_mfma_f32_16x16x32_bf16 v[76:79], v[188:191], v[224:227], v[76:79]
    v_cvt_pk_bf16_f32 v231, v222, v223
    v_mfma_f32_16x16x32_bf16 v[80:83], v[192:195], v[224:227], v[80:83]
    ds_read_b64_tr_b16 v[176:177], v248 offset:9216
    ds_read_b64_tr_b16 v[178:179], v248 offset:13824
    v_mfma_f32_16x16x32_bf16 v[84:87], v[196:199], v[224:227], v[84:87]
    ds_read_b64_tr_b16 v[180:181], v249 offset:9216
    ds_read_b64_tr_b16 v[182:183], v249 offset:13824
    v_mfma_f32_16x16x32_bf16 v[88:91], v[200:203], v[224:227], v[88:91]
    ds_read_b64_tr_b16 v[184:185], v250 offset:9216
    ds_read_b64_tr_b16 v[186:187], v250 offset:13824
    v_mfma_f32_16x16x32_bf16 v[92:95], v[204:207], v[224:227], v[92:95]
    ds_read_b64_tr_b16 v[188:189], v251 offset:9216
    ds_read_b64_tr_b16 v[190:191], v251 offset:13824
    s_barrier
    s_cbranch_vccnz Lrare_57
Lcont_58:
    s_add_u32 s58, s58, 1
    s_and_b32 s58, s58, 3
    s_cmp_eq_u32 s58, 0
    s_cselect_b32 s56, s57, 35840
    v_add_u32 v247, s56, v247
    v_mfma_f32_16x16x32_bf16 v[216:219], v[144:147], v[128:131], v[240:243]
    v_exp_f32 v208, v208
    v_exp_f32 v209, v209
    v_mfma_f32_16x16x32_bf16 v[220:223], v[160:163], v[128:131], v[240:243]
    v_exp_f32 v210, v210
    v_exp_f32 v211, v211
    v_mfma_f32_16x16x32_bf16 v[216:219], v[148:151], v[132:135], v[216:219]
    v_add_f32 v252, v208, v209
    v_add_f32 v253, v210, v211
    v_mfma_f32_16x16x32_bf16 v[220:223], v[164:167], v[132:135], v[220:223]
    ds_read_b64_tr_b16 v[192:193], v248 offset:9344
    ds_read_b64_tr_b16 v[194:195], v248 offset:13952
    v_mfma_f32_16x16x32_bf16 v[216:219], v[152:155], v[136:139], v[216:219]
    v_exp_f32 v212, v212
    v_exp_f32 v213, v213
    v_mfma_f32_16x16x32_bf16 v[220:223], v[168:171], v[136:139], v[220:223]
    v_add_f32 v252, v252, v253
    ds_read_b64_tr_b16 v[196:197], v249 offset:9344
    ds_read_b64_tr_b16 v[198:199], v249 offset:13952
    v_mfma_f32_16x16x32_bf16 v[216:219], v[156:159], v[140:143], v[216:219]
    v_add_f32 v244, v244, v254
    v_add_f32 v253, v212, v213
    v_mfma_f32_16x16x32_bf16 v[220:223], v[172:175], v[140:143], v[220:223]
    ds_read_b64_tr_b16 v[200:201], v250 offset:9344
    ds_read_b64_tr_b16 v[202:203], v250 offset:13952
    v_exp_f32 v214, v214
    v_exp_f32 v215, v215
    v_add_f32 v252, v252, v253
    s_waitcnt lgkmcnt(0)
    v_mfma_f32_16x16x32_bf16 v[0:3], v[176:179], v[228:231], v[0:3]
    ds_read_b64_tr_b16 v[204:205], v251 offset:9344
    ds_read_b64_tr_b16 v[206:207], v251 offset:13952
    v_add_f32 v253, v214, v215
    s_waitcnt lgkmcnt(0)
    v_mfma_f32_16x16x32_bf16 v[4:7], v[180:183], v[228:231], v[4:7]
    ds_read_b128 v[144:147], v247 offset:0
    v_add_f32 v254, v252, v253
    s_waitcnt lgkmcnt(0)
    v_mfma_f32_16x16x32_bf16 v[8:11], v[184:187], v[228:231], v[8:11]
    ds_read_b128 v[160:163], v247 offset:4352
    v_cmp_lt_f32 vcc, s54, v254
    s_waitcnt lgkmcnt(0)
    v_mfma_f32_16x16x32_bf16 v[12:15], v[188:191], v[228:231], v[12:15]
    ds_read_b128 v[148:151], v247 offset:64
    s_waitcnt lgkmcnt(0)
    v_mfma_f32_16x16x32_bf16 v[16:19], v[192:195], v[228:231], v[16:19]
    ds_read_b128 v[164:167], v247 offset:4416
    s_waitcnt lgkmcnt(0)
    v_mfma_f32_16x16x32_bf16 v[20:23], v[196:199], v[228:231], v[20:23]
    ds_read_b128 v[152:155], v247 offset:128
    ds_read_b128 v[168:171], v247 offset:4480
    s_waitcnt lgkmcnt(0)
    v_mfma_f32_16x16x32_bf16 v[24:27], v[200:203], v[228:231], v[24:27]
    v_cvt_pk_bf16_f32 v224, v208, v209
    v_cvt_pk_bf16_f32 v225, v210, v211
    v_cvt_pk_bf16_f32 v226, v212, v213
    v_cvt_pk_bf16_f32 v227, v214, v215
    s_waitcnt lgkmcnt(0)
    v_mfma_f32_16x16x32_bf16 v[28:31], v[204:207], v[228:231], v[28:31]
    s_cbranch_vccnz Lrare_59
Lcont_60:
    s_waitcnt lgkmcnt(0)
    v_mfma_f32_16x16x32_bf16 v[208:211], v[144:147], v[96:99], v[232:235]
    ds_read_b128 v[156:159], v247 offset:192
    ds_read_b128 v[172:175], v247 offset:4544
    s_waitcnt lgkmcnt(0)
    v_mfma_f32_16x16x32_bf16 v[212:215], v[160:163], v[96:99], v[232:235]
    v_exp_f32 v216, v216
    s_waitcnt lgkmcnt(0)
    v_mfma_f32_16x16x32_bf16 v[208:211], v[148:151], v[100:103], v[208:211]
    v_exp_f32 v217, v217
    s_waitcnt lgkmcnt(0)
    v_mfma_f32_16x16x32_bf16 v[212:215], v[164:167], v[100:103], v[212:215]
    v_exp_f32 v218, v218
    v_exp_f32 v219, v219
    s_waitcnt lgkmcnt(0)
    v_mfma_f32_16x16x32_bf16 v[208:211], v[152:155], v[104:107], v[208:211]
    v_add_f32 v252, v216, v217
    v_add_f32 v253, v218, v219
    s_waitcnt lgkmcnt(0)
    v_mfma_f32_16x16x32_bf16 v[212:215], v[168:171], v[104:107], v[212:215]
    v_exp_f32 v220, v220
    v_exp_f32 v221, v221
    v_add_f32 v252, v252, v253
    s_waitcnt lgkmcnt(0)
    v_mfma_f32_16x16x32_bf16 v[208:211], v[156:159], v[108:111], v[208:211]
    v_add_f32 v245, v245, v254
    v_add_f32 v253, v220, v221
    s_waitcnt lgkmcnt(0)
    v_mfma_f32_16x16x32_bf16 v[212:215], v[172:175], v[108:111], v[212:215]
    v_exp_f32 v222, v222
    v_exp_f32 v223, v223
    v_add_f32 v252, v252, v253
    v_mfma_f32_16x16x32_bf16 v[32:35], v[176:179], v[224:227], v[32:35]
    v_add_f32 v253, v222, v223
    v_cvt_pk_bf16_f32 v228, v216, v217
    v_mfma_f32_16x16x32_bf16 v[36:39], v[180:183], v[224:227], v[36:39]
    v_add_f32 v254, v252, v253
    v_cvt_pk_bf16_f32 v229, v218, v219
    v_mfma_f32_16x16x32_bf16 v[40:43], v[184:187], v[224:227], v[40:43]
    v_cmp_lt_f32 vcc, s54, v254
    v_cvt_pk_bf16_f32 v230, v220, v221
    v_mfma_f32_16x16x32_bf16 v[44:47], v[188:191], v[224:227], v[44:47]
    v_cvt_pk_bf16_f32 v231, v222, v223
    v_add_u32 v248, s56, v248
    v_mfma_f32_16x16x32_bf16 v[48:51], v[192:195], v[224:227], v[48:51]
    v_add_u32 v249, s56, v249
    v_add_u32 v250, s56, v250
    v_mfma_f32_16x16x32_bf16 v[52:55], v[196:199], v[224:227], v[52:55]
    v_add_u32 v251, s56, v251
    v_mfma_f32_16x16x32_bf16 v[56:59], v[200:203], v[224:227], v[56:59]
    v_mfma_f32_16x16x32_bf16 v[60:63], v[204:207], v[224:227], v[60:63]
    s_add_u32 s55, s55, 1
    s_cmp_lt_u32 s55, 2
    s_cbranch_scc1 Lramp_61
    s_waitcnt lgkmcnt(0)
.p2align 6
Ltile_48:
    s_cbranch_vccnz Lrare_24
Lcont_25:
    v_mfma_f32_16x16x32_bf16 v[216:219], v[144:147], v[112:115], v[236:239]
    v_exp_f32 v208, v208
    v_mfma_f32_16x16x32_bf16 v[220:223], v[160:163], v[112:115], v[236:239]
    v_exp_f32 v209, v209
    v_mfma_f32_16x16x32_bf16 v[216:219], v[148:151], v[116:119], v[216:219]
    v_exp_f32 v210, v210
    v_mfma_f32_16x16x32_bf16 v[220:223], v[164:167], v[116:119], v[220:223]
    v_exp_f32 v211, v211
    v_add_f32 v252, v208, v209
    v_mfma_f32_16x16x32_bf16 v[216:219], v[152:155], v[120:123], v[216:219]
    v_add_f32 v253, v210, v211
    v_exp_f32 v212, v212
    v_mfma_f32_16x16x32_bf16 v[220:223], v[168:171], v[120:123], v[220:223]
    v_exp_f32 v213, v213
    v_add_f32 v252, v252, v253
    v_mfma_f32_16x16x32_bf16 v[216:219], v[156:159], v[124:127], v[216:219]
    v_add_f32 v246, v246, v254
    v_add_f32 v253, v212, v213
    v_mfma_f32_16x16x32_bf16 v[220:223], v[172:175], v[124:127], v[220:223]
    v_exp_f32 v214, v214
    v_exp_f32 v215, v215
    v_add_f32 v252, v252, v253
    v_mfma_f32_16x16x32_bf16 v[64:67], v[176:179], v[228:231], v[64:67]
    v_add_f32 v253, v214, v215
    v_cvt_pk_bf16_f32 v224, v208, v209
    v_mfma_f32_16x16x32_bf16 v[68:71], v[180:183], v[228:231], v[68:71]
    v_add_f32 v254, v252, v253
    v_cvt_pk_bf16_f32 v225, v210, v211
    v_mfma_f32_16x16x32_bf16 v[72:75], v[184:187], v[228:231], v[72:75]
    v_cmp_lt_f32 vcc, s54, v254
    v_cvt_pk_bf16_f32 v226, v212, v213
    v_mfma_f32_16x16x32_bf16 v[76:79], v[188:191], v[228:231], v[76:79]
    v_cvt_pk_bf16_f32 v227, v214, v215
    v_mfma_f32_16x16x32_bf16 v[80:83], v[192:195], v[228:231], v[80:83]
    ds_read_b64_tr_b16 v[176:177], v248 offset:0
    ds_read_b64_tr_b16 v[178:179], v248 offset:4608
    v_mfma_f32_16x16x32_bf16 v[84:87], v[196:199], v[228:231], v[84:87]
    ds_read_b64_tr_b16 v[180:181], v249 offset:0
    ds_read_b64_tr_b16 v[182:183], v249 offset:4608
    v_mfma_f32_16x16x32_bf16 v[88:91], v[200:203], v[228:231], v[88:91]
    ds_read_b64_tr_b16 v[184:185], v250 offset:0
    ds_read_b64_tr_b16 v[186:187], v250 offset:4608
    v_mfma_f32_16x16x32_bf16 v[92:95], v[204:207], v[228:231], v[92:95]
    ds_read_b64_tr_b16 v[188:189], v251 offset:0
    ds_read_b64_tr_b16 v[190:191], v251 offset:4608
    s_cbranch_vccnz Lrare_26
Lcont_27:
    v_mfma_f32_16x16x32_bf16 v[208:211], v[144:147], v[128:131], v[240:243]
    v_exp_f32 v216, v216
    v_exp_f32 v217, v217
    v_mfma_f32_16x16x32_bf16 v[212:215], v[160:163], v[128:131], v[240:243]
    v_exp_f32 v218, v218
    v_exp_f32 v219, v219
    v_mfma_f32_16x16x32_bf16 v[208:211], v[148:151], v[132:135], v[208:211]
    v_add_f32 v252, v216, v217
    v_add_f32 v253, v218, v219
    v_mfma_f32_16x16x32_bf16 v[212:215], v[164:167], v[132:135], v[212:215]
    ds_read_b64_tr_b16 v[192:193], v248 offset:128
    ds_read_b64_tr_b16 v[194:195], v248 offset:4736
    v_mfma_f32_16x16x32_bf16 v[208:211], v[152:155], v[136:139], v[208:211]
    v_exp_f32 v220, v220
    v_exp_f32 v221, v221
    v_mfma_f32_16x16x32_bf16 v[212:215], v[168:171], v[136:139], v[212:215]
    v_add_f32 v252, v252, v253
    ds_read_b64_tr_b16 v[196:197], v249 offset:128
    ds_read_b64_tr_b16 v[198:199], v249 offset:4736
    v_mfma_f32_16x16x32_bf16 v[208:211], v[156:159], v[140:143], v[208:211]
    v_add_f32 v244, v244, v254
    v_add_f32 v253, v220, v221
    v_mfma_f32_16x16x32_bf16 v[212:215], v[172:175], v[140:143], v[212:215]
    ds_read_b64_tr_b16 v[200:201], v250 offset:128
    ds_read_b64_tr_b16 v[202:203], v250 offset:4736
    v_exp_f32 v222, v222
    v_exp_f32 v223, v223
    v_add_f32 v252, v252, v253
    s_waitcnt lgkmcnt(12)
    v_mfma_f32_16x16x32_bf16 v[0:3], v[176:179], v[224:227], v[0:3]
    ds_read_b64_tr_b16 v[204:205], v251 offset:128
    ds_read_b64_tr_b16 v[206:207], v251 offset:4736
    v_add_f32 v253, v222, v223
    s_waitcnt lgkmcnt(12)
    v_mfma_f32_16x16x32_bf16 v[4:7], v[180:183], v[224:227], v[4:7]
    ds_read_b128 v[144:147], v247 offset:8704
    v_add_f32 v254, v252, v253
    s_waitcnt lgkmcnt(11)
    v_mfma_f32_16x16x32_bf16 v[8:11], v[184:187], v[224:227], v[8:11]
    ds_read_b128 v[160:163], v247 offset:13056
    v_cmp_lt_f32 vcc, s54, v254
    s_waitcnt lgkmcnt(10)
    v_mfma_f32_16x16x32_bf16 v[12:15], v[188:191], v[224:227], v[12:15]
    ds_read_b128 v[148:151], v247 offset:8768
    s_waitcnt lgkmcnt(9)
    v_mfma_f32_16x16x32_bf16 v[16:19], v[192:195], v[224:227], v[16:19]
    ds_read_b128 v[164:167], v247 offset:13120
    s_waitcnt lgkmcnt(8)
    v_mfma_f32_16x16x32_bf16 v[20:23], v[196:199], v[224:227], v[20:23]
    ds_read_b128 v[152:155], v247 offset:8832
    ds_read_b128 v[168:171], v247 offset:13184
    s_waitcnt lgkmcnt(8)
    v_mfma_f32_16x16x32_bf16 v[24:27], v[200:203], v[224:227], v[24:27]
    v_cvt_pk_bf16_f32 v228, v216, v217
    v_cvt_pk_bf16_f32 v229, v218, v219
    v_cvt_pk_bf16_f32 v230, v220, v221
    v_cvt_pk_bf16_f32 v231, v222, v223
    s_waitcnt lgkmcnt(6)
    v_mfma_f32_16x16x32_bf16 v[28:31], v[204:207], v[224:227], v[28:31]
    s_cbranch_vccnz Lrare_28
Lcont_29:
    s_waitcnt lgkmcnt(5)
    v_mfma_f32_16x16x32_bf16 v[216:219], v[144:147], v[96:99], v[232:235]
    ds_read_b128 v[156:159], v247 offset:8896
    ds_read_b128 v[172:175], v247 offset:13248
    s_waitcnt lgkmcnt(6)
    v_mfma_f32_16x16x32_bf16 v[220:223], v[160:163], v[96:99], v[232:235]
    v_exp_f32 v208, v208
    s_waitcnt lgkmcnt(5)
    v_mfma_f32_16x16x32_bf16 v[216:219], v[148:151], v[100:103], v[216:219]
    v_exp_f32 v209, v209
    s_waitcnt lgkmcnt(4)
    v_mfma_f32_16x16x32_bf16 v[220:223], v[164:167], v[100:103], v[220:223]
    v_exp_f32 v210, v210
    v_exp_f32 v211, v211
    s_waitcnt lgkmcnt(3)
    v_mfma_f32_16x16x32_bf16 v[216:219], v[152:155], v[104:107], v[216:219]
    v_add_f32 v252, v208, v209
    v_add_f32 v253, v210, v211
    s_waitcnt lgkmcnt(2)
    v_mfma_f32_16x16x32_bf16 v[220:223], v[168:171], v[104:107], v[220:223]
    v_exp_f32 v212, v212
    v_exp_f32 v213, v213
    v_add_f32 v252, v252, v253
    s_waitcnt lgkmcnt(1)
    v_mfma_f32_16x16x32_bf16 v[216:219], v[156:159], v[108:111], v[216:219]
    v_add_f32 v245, v245, v254
    v_add_f32 v253, v212, v213
    s_waitcnt lgkmcnt(0)
    v_mfma_f32_16x16x32_bf16 v[220:223], v[172:175], v[108:111], v[220:223]
    v_exp_f32 v214, v214
    v_exp_f32 v215, v215
    v_add_f32 v252, v252, v253
    v_mfma_f32_16x16x32_bf16 v[32:35], v[176:179], v[228:231], v[32:35]
    v_add_f32 v253, v214, v215
    v_cvt_pk_bf16_f32 v224, v208, v209
    v_mfma_f32_16x16x32_bf16 v[36:39], v[180:183], v[228:231], v[36:39]
    v_add_f32 v254, v252, v253
    v_cvt_pk_bf16_f32 v225, v210, v211
    v_mfma_f32_16x16x32_bf16 v[40:43], v[184:187], v[228:231], v[40:43]
    v_cmp_lt_f32 vcc, s54, v254
    v_cvt_pk_bf16_f32 v226, v212, v213
    v_mfma_f32_16x16x32_bf16 v[44:47], v[188:191], v[228:231], v[44:47]
    v_cvt_pk_bf16_f32 v227, v214, v215
    v_mfma_f32_16x16x32_bf16 v[48:51], v[192:195], v[228:231], v[48:51]
    v_mfma_f32_16x16x32_bf16 v[52:55], v[196:199], v[228:231], v[52:55]
    v_mfma_f32_16x16x32_bf16 v[56:59], v[200:203], v[228:231], v[56:59]
    v_mfma_f32_16x16x32_bf16 v[60:63], v[204:207], v[228:231], v[60:63]
    s_cbranch_vccnz Lrare_30
Lcont_31:
    v_mfma_f32_16x16x32_bf16 v[208:211], v[144:147], v[112:115], v[236:239]
    v_exp_f32 v216, v216
    v_mfma_f32_16x16x32_bf16 v[212:215], v[160:163], v[112:115], v[236:239]
    v_exp_f32 v217, v217
    v_mfma_f32_16x16x32_bf16 v[208:211], v[148:151], v[116:119], v[208:211]
    v_exp_f32 v218, v218
    v_mfma_f32_16x16x32_bf16 v[212:215], v[164:167], v[116:119], v[212:215]
    v_exp_f32 v219, v219
    v_add_f32 v252, v216, v217
    v_mfma_f32_16x16x32_bf16 v[208:211], v[152:155], v[120:123], v[208:211]
    v_add_f32 v253, v218, v219
    v_exp_f32 v220, v220
    v_mfma_f32_16x16x32_bf16 v[212:215], v[168:171], v[120:123], v[212:215]
    v_exp_f32 v221, v221
    v_add_f32 v252, v252, v253
    v_mfma_f32_16x16x32_bf16 v[208:211], v[156:159], v[124:127], v[208:211]
    v_add_f32 v246, v246, v254
    v_add_f32 v253, v220, v221
    v_mfma_f32_16x16x32_bf16 v[212:215], v[172:175], v[124:127], v[212:215]
    v_exp_f32 v222, v222
    v_exp_f32 v223, v223
    v_add_f32 v252, v252, v253
    v_mfma_f32_16x16x32_bf16 v[64:67], v[176:179], v[224:227], v[64:67]
    v_add_f32 v253, v222, v223
    v_cvt_pk_bf16_f32 v228, v216, v217
    v_mfma_f32_16x16x32_bf16 v[68:71], v[180:183], v[224:227], v[68:71]
    v_add_f32 v254, v252, v253
    v_cvt_pk_bf16_f32 v229, v218, v219
    v_mfma_f32_16x16x32_bf16 v[72:75], v[184:187], v[224:227], v[72:75]
    v_cmp_lt_f32 vcc, s54, v254
    v_cvt_pk_bf16_f32 v230, v220, v221
    v_mfma_f32_16x16x32_bf16 v[76:79], v[188:191], v[224:227], v[76:79]
    v_cvt_pk_bf16_f32 v231, v222, v223
    v_mfma_f32_16x16x32_bf16 v[80:83], v[192:195], v[224:227], v[80:83]
    ds_read_b64_tr_b16 v[176:177], v248 offset:9216
    ds_read_b64_tr_b16 v[178:179], v248 offset:13824
    v_mfma_f32_16x16x32_bf16 v[84:87], v[196:199], v[224:227], v[84:87]
    ds_read_b64_tr_b16 v[180:181], v249 offset:9216
    ds_read_b64_tr_b16 v[182:183], v249 offset:13824
    v_mfma_f32_16x16x32_bf16 v[88:91], v[200:203], v[224:227], v[88:91]
    ds_read_b64_tr_b16 v[184:185], v250 offset:9216
    ds_read_b64_tr_b16 v[186:187], v250 offset:13824
    v_mfma_f32_16x16x32_bf16 v[92:95], v[204:207], v[224:227], v[92:95]
    ds_read_b64_tr_b16 v[188:189], v251 offset:9216
    ds_read_b64_tr_b16 v[190:191], v251 offset:13824
    s_barrier
    s_cbranch_vccnz Lrare_32
Lcont_33:
    s_add_u32 s58, s58, 1
    s_and_b32 s58, s58, 3
    s_cmp_eq_u32 s58, 0
    s_cselect_b32 s56, s57, 35840
    v_add_u32 v247, s56, v247
    v_mfma_f32_16x16x32_bf16 v[216:219], v[144:147], v[128:131], v[240:243]
    v_exp_f32 v208, v208
    v_exp_f32 v209, v209
    v_mfma_f32_16x16x32_bf16 v[220:223], v[160:163], v[128:131], v[240:243]
    v_exp_f32 v210, v210
    v_exp_f32 v211, v211
    v_mfma_f32_16x16x32_bf16 v[216:219], v[148:151], v[132:135], v[216:219]
    v_add_f32 v252, v208, v209
    v_add_f32 v253, v210, v211
    v_mfma_f32_16x16x32_bf16 v[220:223], v[164:167], v[132:135], v[220:223]
    ds_read_b64_tr_b16 v[192:193], v248 offset:9344
    ds_read_b64_tr_b16 v[194:195], v248 offset:13952
    v_mfma_f32_16x16x32_bf16 v[216:219], v[152:155], v[136:139], v[216:219]
    v_exp_f32 v212, v212
    v_exp_f32 v213, v213
    v_mfma_f32_16x16x32_bf16 v[220:223], v[168:171], v[136:139], v[220:223]
    v_add_f32 v252, v252, v253
    ds_read_b64_tr_b16 v[196:197], v249 offset:9344
    ds_read_b64_tr_b16 v[198:199], v249 offset:13952
    v_mfma_f32_16x16x32_bf16 v[216:219], v[156:159], v[140:143], v[216:219]
    v_add_f32 v244, v244, v254
    v_add_f32 v253, v212, v213
    v_mfma_f32_16x16x32_bf16 v[220:223], v[172:175], v[140:143], v[220:223]
    ds_read_b64_tr_b16 v[200:201], v250 offset:9344
    ds_read_b64_tr_b16 v[202:203], v250 offset:13952
    v_exp_f32 v214, v214
    v_exp_f32 v215, v215
    v_add_f32 v252, v252, v253
    s_waitcnt lgkmcnt(12)
    v_mfma_f32_16x16x32_bf16 v[0:3], v[176:179], v[228:231], v[0:3]
    ds_read_b64_tr_b16 v[204:205], v251 offset:9344
    ds_read_b64_tr_b16 v[206:207], v251 offset:13952
    v_add_f32 v253, v214, v215
    s_waitcnt lgkmcnt(12)
    v_mfma_f32_16x16x32_bf16 v[4:7], v[180:183], v[228:231], v[4:7]
    ds_read_b128 v[144:147], v247 offset:0
    v_add_f32 v254, v252, v253
    s_waitcnt lgkmcnt(11)
    v_mfma_f32_16x16x32_bf16 v[8:11], v[184:187], v[228:231], v[8:11]
    ds_read_b128 v[160:163], v247 offset:4352
    v_cmp_lt_f32 vcc, s54, v254
    s_waitcnt lgkmcnt(10)
    v_mfma_f32_16x16x32_bf16 v[12:15], v[188:191], v[228:231], v[12:15]
    ds_read_b128 v[148:151], v247 offset:64
    s_waitcnt lgkmcnt(9)
    v_mfma_f32_16x16x32_bf16 v[16:19], v[192:195], v[228:231], v[16:19]
    ds_read_b128 v[164:167], v247 offset:4416
    s_waitcnt lgkmcnt(8)
    v_mfma_f32_16x16x32_bf16 v[20:23], v[196:199], v[228:231], v[20:23]
    ds_read_b128 v[152:155], v247 offset:128
    ds_read_b128 v[168:171], v247 offset:4480
    s_waitcnt lgkmcnt(8)
    v_mfma_f32_16x16x32_bf16 v[24:27], v[200:203], v[228:231], v[24:27]
    v_cvt_pk_bf16_f32 v224, v208, v209
    v_cvt_pk_bf16_f32 v225, v210, v211
    v_cvt_pk_bf16_f32 v226, v212, v213
    v_cvt_pk_bf16_f32 v227, v214, v215
    s_waitcnt lgkmcnt(6)
    v_mfma_f32_16x16x32_bf16 v[28:31], v[204:207], v[228:231], v[28:31]
    s_cbranch_vccnz Lrare_34
Lcont_35:
    s_waitcnt lgkmcnt(5)
    v_mfma_f32_16x16x32_bf16 v[208:211], v[144:147], v[96:99], v[232:235]
    ds_read_b128 v[156:159], v247 offset:192
    ds_read_b128 v[172:175], v247 offset:4544
    s_waitcnt lgkmcnt(6)
    v_mfma_f32_16x16x32_bf16 v[212:215], v[160:163], v[96:99], v[232:235]
    v_exp_f32 v216, v216
    s_waitcnt lgkmcnt(5)
    v_mfma_f32_16x16x32_bf16 v[208:211], v[148:151], v[100:103], v[208:211]
    v_exp_f32 v217, v217
    s_waitcnt lgkmcnt(4)
    v_mfma_f32_16x16x32_bf16 v[212:215], v[164:167], v[100:103], v[212:215]
    v_exp_f32 v218, v218
    v_exp_f32 v219, v219
    s_waitcnt lgkmcnt(3)
    v_mfma_f32_16x16x32_bf16 v[208:211], v[152:155], v[104:107], v[208:211]
    v_add_f32 v252, v216, v217
    v_add_f32 v253, v218, v219
    s_waitcnt lgkmcnt(2)
    v_mfma_f32_16x16x32_bf16 v[212:215], v[168:171], v[104:107], v[212:215]
    v_exp_f32 v220, v220
    v_exp_f32 v221, v221
    v_add_f32 v252, v252, v253
    s_waitcnt lgkmcnt(1)
    v_mfma_f32_16x16x32_bf16 v[208:211], v[156:159], v[108:111], v[208:211]
    v_add_f32 v245, v245, v254
    v_add_f32 v253, v220, v221
    s_waitcnt lgkmcnt(0)
    v_mfma_f32_16x16x32_bf16 v[212:215], v[172:175], v[108:111], v[212:215]
    v_exp_f32 v222, v222
    v_exp_f32 v223, v223
    v_add_f32 v252, v252, v253
    v_mfma_f32_16x16x32_bf16 v[32:35], v[176:179], v[224:227], v[32:35]
    v_add_f32 v253, v222, v223
    v_cvt_pk_bf16_f32 v228, v216, v217
    v_mfma_f32_16x16x32_bf16 v[36:39], v[180:183], v[224:227], v[36:39]
    v_add_f32 v254, v252, v253
    v_cvt_pk_bf16_f32 v229, v218, v219
    v_mfma_f32_16x16x32_bf16 v[40:43], v[184:187], v[224:227], v[40:43]
    v_cmp_lt_f32 vcc, s54, v254
    v_cvt_pk_bf16_f32 v230, v220, v221
    v_mfma_f32_16x16x32_bf16 v[44:47], v[188:191], v[224:227], v[44:47]
    v_cvt_pk_bf16_f32 v231, v222, v223
    v_add_u32 v248, s56, v248
    v_mfma_f32_16x16x32_bf16 v[48:51], v[192:195], v[224:227], v[48:51]
    v_add_u32 v249, s56, v249
    v_add_u32 v250, s56, v250
    v_mfma_f32_16x16x32_bf16 v[52:55], v[196:199], v[224:227], v[52:55]
    v_add_u32 v251, s56, v251
    v_mfma_f32_16x16x32_bf16 v[56:59], v[200:203], v[224:227], v[56:59]
    v_mfma_f32_16x16x32_bf16 v[60:63], v[204:207], v[224:227], v[60:63]
    s_add_u32 s55, s55, 1
    s_cmp_lt_u32 s55, 16
    s_cbranch_scc1 Ltile_48
    s_waitcnt lgkmcnt(0)
    s_cbranch_vccnz Lrare_62
Lcont_63:
    v_add_f32 v246, v246, v254
    s_barrier
    s_nop 0
    v_mfma_f32_16x16x32_bf16 v[64:67], v[176:179], v[228:231], v[64:67]
    v_mov_b32 v232, v244
    v_mov_b32 v233, v245
    v_mov_b32 v234, v246
    v_permlane32_swap_b32 v244, v232
    v_permlane32_swap_b32 v245, v233
    v_permlane32_swap_b32 v246, v234
    v_add_f32 v244, v244, v232
    v_mfma_f32_16x16x32_bf16 v[68:71], v[180:183], v[228:231], v[68:71]
    v_add_f32 v245, v245, v233
    v_add_f32 v246, v246, v234
    v_mov_b32 v232, v244
    v_mov_b32 v233, v245
    v_mov_b32 v234, v246
    v_permlane16_swap_b32 v244, v232
    v_permlane16_swap_b32 v245, v233
    v_mfma_f32_16x16x32_bf16 v[72:75], v[184:187], v[228:231], v[72:75]
    v_permlane16_swap_b32 v246, v234
    v_add_f32 v244, v244, v232
    v_add_f32 v245, v245, v233
    v_add_f32 v246, v246, v234
    v_rcp_f32 v244, v244
    v_rcp_f32 v245, v245
    v_rcp_f32 v246, v246
    v_mfma_f32_16x16x32_bf16 v[76:79], v[188:191], v[228:231], v[76:79]
    v_lshlrev_b32 v148, 4, v255
    s_mul_i32 s48, s44, 12288
    s_add_u32 s48, s48, 107520
    v_add_u32 v240, s48, v148
    s_xor_b32 s50, s44, 2
    s_mul_i32 s48, s50, 12288
    s_add_u32 s48, s48, 107520
    v_mfma_f32_16x16x32_bf16 v[80:83], v[192:195], v[228:231], v[80:83]
    v_add_u32 v241, s48, v148
    v_lshrrev_b32 v144, 4, v255
    v_bfe_u32 v145, v255, 2, 2
    v_and_b32 v146, 3, v255
    v_lshlrev_b32 v147, 2, v144
    v_add_u32 v147, v147, v145
    v_lshrrev_b32 v144, 1, v147
    v_mfma_f32_16x16x32_bf16 v[84:87], v[196:199], v[228:231], v[84:87]
    v_and_b32 v144, 3, v144
    v_lshlrev_b32 v144, 5, v144
    v_lshlrev_b32 v147, 7, v147
    v_add_u32 v147, v147, v144
    v_lshlrev_b32 v146, 3, v146
    v_add_u32 v147, v147, v146
    s_lshl_b32 s48, s64, 6
    v_mfma_f32_16x16x32_bf16 v[88:91], v[200:203], v[228:231], v[88:91]
    v_xor_b32 v147, s48, v147
    s_lshl_b32 s48, s64, 14
    s_xor_b32 s49, s48, 16384
    v_add_u32 v224, s48, v147
    v_xor_b32 v225, 32, v224
    v_add_u32 v226, s49, v147
    v_xor_b32 v227, 32, v226
    v_mfma_f32_16x16x32_bf16 v[92:95], v[204:207], v[228:231], v[92:95]
    v_pk_mul_f32 v[0:1], v[0:1], v[244:245] op_sel_hi:[1,0]
    v_pk_mul_f32 v[4:5], v[4:5], v[244:245] op_sel_hi:[1,0]
    v_pk_mul_f32 v[2:3], v[2:3], v[244:245] op_sel_hi:[1,0]
    v_pk_mul_f32 v[6:7], v[6:7], v[244:245] op_sel_hi:[1,0]
    v_cvt_pk_bf16_f32 v96, v0, v1
    v_cvt_pk_bf16_f32 v97, v2, v3
    v_cvt_pk_bf16_f32 v98, v4, v5
    v_cvt_pk_bf16_f32 v99, v6, v7
    ds_write_b128 v240, v[96:99] offset:0
    v_pk_mul_f32 v[8:9], v[8:9], v[244:245] op_sel_hi:[1,0]
    v_pk_mul_f32 v[12:13], v[12:13], v[244:245] op_sel_hi:[1,0]
    v_pk_mul_f32 v[10:11], v[10:11], v[244:245] op_sel_hi:[1,0]
    v_pk_mul_f32 v[14:15], v[14:15], v[244:245] op_sel_hi:[1,0]
    v_cvt_pk_bf16_f32 v108, v8, v9
    v_cvt_pk_bf16_f32 v109, v10, v11
    v_cvt_pk_bf16_f32 v110, v12, v13
    v_cvt_pk_bf16_f32 v111, v14, v15
    ds_write_b128 v240, v[108:111] offset:3072
    v_pk_mul_f32 v[16:17], v[16:17], v[244:245] op_sel_hi:[1,0]
    v_pk_mul_f32 v[20:21], v[20:21], v[244:245] op_sel_hi:[1,0]
    v_pk_mul_f32 v[18:19], v[18:19], v[244:245] op_sel_hi:[1,0]
    v_pk_mul_f32 v[22:23], v[22:23], v[244:245] op_sel_hi:[1,0]
    v_cvt_pk_bf16_f32 v120, v16, v17
    v_cvt_pk_bf16_f32 v121, v18, v19
    v_cvt_pk_bf16_f32 v122, v20, v21
    v_cvt_pk_bf16_f32 v123, v22, v23
    ds_write_b128 v240, v[120:123] offset:6144
    v_pk_mul_f32 v[24:25], v[24:25], v[244:245] op_sel_hi:[1,0]
    v_pk_mul_f32 v[28:29], v[28:29], v[244:245] op_sel_hi:[1,0]
    v_pk_mul_f32 v[26:27], v[26:27], v[244:245] op_sel_hi:[1,0]
    v_pk_mul_f32 v[30:31], v[30:31], v[244:245] op_sel_hi:[1,0]
    v_cvt_pk_bf16_f32 v132, v24, v25
    v_cvt_pk_bf16_f32 v133, v26, v27
    v_cvt_pk_bf16_f32 v134, v28, v29
    v_cvt_pk_bf16_f32 v135, v30, v31
    ds_write_b128 v240, v[132:135] offset:9216
    v_pk_mul_f32 v[32:33], v[32:33], v[244:245] op_sel:[0,1] op_sel_hi:[1,1]
    v_pk_mul_f32 v[36:37], v[36:37], v[244:245] op_sel:[0,1] op_sel_hi:[1,1]
    v_pk_mul_f32 v[34:35], v[34:35], v[244:245] op_sel:[0,1] op_sel_hi:[1,1]
    v_pk_mul_f32 v[38:39], v[38:39], v[244:245] op_sel:[0,1] op_sel_hi:[1,1]
    v_cvt_pk_bf16_f32 v100, v32, v33
    v_cvt_pk_bf16_f32 v101, v34, v35
    v_cvt_pk_bf16_f32 v102, v36, v37
    v_cvt_pk_bf16_f32 v103, v38, v39
    ds_write_b128 v240, v[100:103] offset:1024
    v_pk_mul_f32 v[40:41], v[40:41], v[244:245] op_sel:[0,1] op_sel_hi:[1,1]
    v_pk_mul_f32 v[44:45], v[44:45], v[244:245] op_sel:[0,1] op_sel_hi:[1,1]
    v_pk_mul_f32 v[42:43], v[42:43], v[244:245] op_sel:[0,1] op_sel_hi:[1,1]
    v_pk_mul_f32 v[46:47], v[46:47], v[244:245] op_sel:[0,1] op_sel_hi:[1,1]
    v_cvt_pk_bf16_f32 v112, v40, v41
    v_cvt_pk_bf16_f32 v113, v42, v43
    v_cvt_pk_bf16_f32 v114, v44, v45
    v_cvt_pk_bf16_f32 v115, v46, v47
    ds_write_b128 v240, v[112:115] offset:4096
    v_pk_mul_f32 v[48:49], v[48:49], v[244:245] op_sel:[0,1] op_sel_hi:[1,1]
    v_pk_mul_f32 v[52:53], v[52:53], v[244:245] op_sel:[0,1] op_sel_hi:[1,1]
    v_pk_mul_f32 v[50:51], v[50:51], v[244:245] op_sel:[0,1] op_sel_hi:[1,1]
    v_pk_mul_f32 v[54:55], v[54:55], v[244:245] op_sel:[0,1] op_sel_hi:[1,1]
    v_cvt_pk_bf16_f32 v124, v48, v49
    v_cvt_pk_bf16_f32 v125, v50, v51
    v_cvt_pk_bf16_f32 v126, v52, v53
    v_cvt_pk_bf16_f32 v127, v54, v55
    ds_write_b128 v240, v[124:127] offset:7168
    v_pk_mul_f32 v[56:57], v[56:57], v[244:245] op_sel:[0,1] op_sel_hi:[1,1]
    v_pk_mul_f32 v[60:61], v[60:61], v[244:245] op_sel:[0,1] op_sel_hi:[1,1]
    v_pk_mul_f32 v[58:59], v[58:59], v[244:245] op_sel:[0,1] op_sel_hi:[1,1]
    v_pk_mul_f32 v[62:63], v[62:63], v[244:245] op_sel:[0,1] op_sel_hi:[1,1]
    v_cvt_pk_bf16_f32 v136, v56, v57
    v_cvt_pk_bf16_f32 v137, v58, v59
    v_cvt_pk_bf16_f32 v138, v60, v61
    v_cvt_pk_bf16_f32 v139, v62, v63
    ds_write_b128 v240, v[136:139] offset:10240
    s_nop 1
    v_pk_mul_f32 v[64:65], v[64:65], v[246:247] op_sel_hi:[1,0]
    v_pk_mul_f32 v[68:69], v[68:69], v[246:247] op_sel_hi:[1,0]
    v_pk_mul_f32 v[66:67], v[66:67], v[246:247] op_sel_hi:[1,0]
    v_pk_mul_f32 v[70:71], v[70:71], v[246:247] op_sel_hi:[1,0]
    v_cvt_pk_bf16_f32 v104, v64, v65
    v_cvt_pk_bf16_f32 v105, v66, v67
    v_cvt_pk_bf16_f32 v106, v68, v69
    v_cvt_pk_bf16_f32 v107, v70, v71
    ds_write_b128 v240, v[104:107] offset:2048
    v_pk_mul_f32 v[72:73], v[72:73], v[246:247] op_sel_hi:[1,0]
    v_pk_mul_f32 v[76:77], v[76:77], v[246:247] op_sel_hi:[1,0]
    v_pk_mul_f32 v[74:75], v[74:75], v[246:247] op_sel_hi:[1,0]
    v_pk_mul_f32 v[78:79], v[78:79], v[246:247] op_sel_hi:[1,0]
    v_cvt_pk_bf16_f32 v116, v72, v73
    v_cvt_pk_bf16_f32 v117, v74, v75
    v_cvt_pk_bf16_f32 v118, v76, v77
    v_cvt_pk_bf16_f32 v119, v78, v79
    ds_write_b128 v240, v[116:119] offset:5120
    v_pk_mul_f32 v[80:81], v[80:81], v[246:247] op_sel_hi:[1,0]
    v_pk_mul_f32 v[84:85], v[84:85], v[246:247] op_sel_hi:[1,0]
    v_pk_mul_f32 v[82:83], v[82:83], v[246:247] op_sel_hi:[1,0]
    v_pk_mul_f32 v[86:87], v[86:87], v[246:247] op_sel_hi:[1,0]
    v_cvt_pk_bf16_f32 v128, v80, v81
    v_cvt_pk_bf16_f32 v129, v82, v83
    v_cvt_pk_bf16_f32 v130, v84, v85
    v_cvt_pk_bf16_f32 v131, v86, v87
    ds_write_b128 v240, v[128:131] offset:8192
    v_pk_mul_f32 v[88:89], v[88:89], v[246:247] op_sel_hi:[1,0]
    v_pk_mul_f32 v[92:93], v[92:93], v[246:247] op_sel_hi:[1,0]
    v_pk_mul_f32 v[90:91], v[90:91], v[246:247] op_sel_hi:[1,0]
    v_pk_mul_f32 v[94:95], v[94:95], v[246:247] op_sel_hi:[1,0]
    v_cvt_pk_bf16_f32 v140, v88, v89
    v_cvt_pk_bf16_f32 v141, v90, v91
    v_cvt_pk_bf16_f32 v142, v92, v93
    v_cvt_pk_bf16_f32 v143, v94, v95
    ds_write_b128 v240, v[140:143] offset:11264
    s_waitcnt lgkmcnt(0)
    s_barrier
    ds_read_b128 v[144:147], v241 offset:0
    ds_read_b128 v[148:151], v241 offset:1024
    ds_read_b128 v[152:155], v241 offset:2048
    ds_read_b128 v[156:159], v241 offset:3072
    ds_read_b128 v[160:163], v241 offset:4096
    ds_read_b128 v[164:167], v241 offset:5120
    ds_read_b128 v[168:171], v241 offset:6144
    ds_read_b128 v[172:175], v241 offset:7168
    ds_read_b128 v[176:179], v241 offset:8192
    ds_read_b128 v[180:183], v241 offset:9216
    ds_read_b128 v[184:187], v241 offset:10240
    ds_read_b128 v[188:191], v241 offset:11264
    ds_read_b64_tr_b16 v[192:193], v224 offset:0
    ds_read_b64_tr_b16 v[194:195], v224 offset:2048
    ds_read_b64_tr_b16 v[196:197], v225 offset:0
    ds_read_b64_tr_b16 v[198:199], v225 offset:2048
    ds_read_b64_tr_b16 v[200:201], v224 offset:4096
    ds_read_b64_tr_b16 v[202:203], v224 offset:6144
    ds_read_b64_tr_b16 v[204:205], v225 offset:4096
    ds_read_b64_tr_b16 v[206:207], v225 offset:6144
    ds_read_b64_tr_b16 v[208:209], v224 offset:8192
    ds_read_b64_tr_b16 v[210:211], v224 offset:10240
    ds_read_b64_tr_b16 v[212:213], v225 offset:8192
    ds_read_b64_tr_b16 v[214:215], v225 offset:10240
    v_lshlrev_b32 v252, 4, v255
    s_mul_i32 s48, s44, 3072
    s_add_u32 s48, s48, 143360
    v_add_u32 v229, s48, v252
    s_mul_i32 s48, s44, 35840
    s_add_u32 s48, s48, 32768
    v_add_u32 v231, s48, v252
    v_add_u32 v230, 156672, v252
    s_mov_b32 s58, 0
    s_mov_b32 s69, 0
    s_mov_b32 s57, 0xfffe5c00
    s_mov_b32 s55, 0
Lo_64:
    s_waitcnt lgkmcnt(8)
    v_mfma_f32_16x16x32_bf16 v[0:3], v[192:195], v[96:99], 0
    ds_read_b64_tr_b16 v[216:217], v224 offset:12288
    v_mfma_f32_16x16x32_bf16 v[4:7], v[192:195], v[100:103], 0
    ds_read_b64_tr_b16 v[218:219], v224 offset:14336
    v_mfma_f32_16x16x32_bf16 v[8:11], v[192:195], v[104:107], 0
    ds_read_b64_tr_b16 v[220:221], v225 offset:12288
    v_mfma_f32_16x16x32_bf16 v[12:15], v[196:199], v[96:99], 0
    ds_read_b64_tr_b16 v[222:223], v225 offset:14336
    v_mfma_f32_16x16x32_bf16 v[16:19], v[196:199], v[100:103], 0
    v_add_u32 v226, s69, v226
    v_mfma_f32_16x16x32_bf16 v[20:23], v[196:199], v[104:107], 0
    v_add_u32 v227, s69, v227
    s_waitcnt lgkmcnt(8)
    v_mfma_f32_16x16x32_bf16 v[0:3], v[200:203], v[108:111], v[0:3]
    ds_read_b64_tr_b16 v[192:193], v226 offset:0
    v_cvt_pk_bf16_f32 v60, v24, v25
    v_mfma_f32_16x16x32_bf16 v[4:7], v[200:203], v[112:115], v[4:7]
    ds_read_b64_tr_b16 v[194:195], v226 offset:2048
    v_cvt_pk_bf16_f32 v61, v26, v27
    v_mfma_f32_16x16x32_bf16 v[8:11], v[200:203], v[116:119], v[8:11]
    ds_read_b64_tr_b16 v[196:197], v227 offset:0
    v_cvt_pk_bf16_f32 v62, v36, v37
    v_mfma_f32_16x16x32_bf16 v[12:15], v[204:207], v[108:111], v[12:15]
    ds_read_b64_tr_b16 v[198:199], v227 offset:2048
    v_cvt_pk_bf16_f32 v63, v38, v39
    v_mfma_f32_16x16x32_bf16 v[16:19], v[204:207], v[112:115], v[16:19]
    v_cvt_pk_bf16_f32 v64, v28, v29
    v_mfma_f32_16x16x32_bf16 v[20:23], v[204:207], v[116:119], v[20:23]
    ds_write_b128 v230, v[60:63] offset:0
    s_waitcnt lgkmcnt(8)
    v_mfma_f32_16x16x32_bf16 v[0:3], v[208:211], v[120:123], v[0:3]
    ds_read_b64_tr_b16 v[200:201], v226 offset:4096
    v_cvt_pk_bf16_f32 v65, v30, v31
    v_mfma_f32_16x16x32_bf16 v[4:7], v[208:211], v[124:127], v[4:7]
    ds_read_b64_tr_b16 v[202:203], v226 offset:6144
    v_cvt_pk_bf16_f32 v66, v40, v41
    v_mfma_f32_16x16x32_bf16 v[8:11], v[208:211], v[128:131], v[8:11]
    ds_read_b64_tr_b16 v[204:205], v227 offset:4096
    v_cvt_pk_bf16_f32 v67, v42, v43
    v_mfma_f32_16x16x32_bf16 v[12:15], v[212:215], v[120:123], v[12:15]
    ds_read_b64_tr_b16 v[206:207], v227 offset:6144
    v_cvt_pk_bf16_f32 v68, v32, v33
    v_mfma_f32_16x16x32_bf16 v[16:19], v[212:215], v[124:127], v[16:19]
    v_mfma_f32_16x16x32_bf16 v[20:23], v[212:215], v[128:131], v[20:23]
    ds_write_b128 v230, v[64:67] offset:1024
    s_waitcnt lgkmcnt(8)
    v_mfma_f32_16x16x32_bf16 v[0:3], v[216:219], v[132:135], v[0:3]
    ds_read_b64_tr_b16 v[208:209], v226 offset:8192
    v_cvt_pk_bf16_f32 v69, v34, v35
    v_mfma_f32_16x16x32_bf16 v[4:7], v[216:219], v[136:139], v[4:7]
    ds_read_b64_tr_b16 v[210:211], v226 offset:10240
    v_cvt_pk_bf16_f32 v70, v44, v45
    v_mfma_f32_16x16x32_bf16 v[8:11], v[216:219], v[140:143], v[8:11]
    ds_read_b64_tr_b16 v[212:213], v227 offset:8192
    v_cvt_pk_bf16_f32 v71, v46, v47
    v_mfma_f32_16x16x32_bf16 v[12:15], v[220:223], v[132:135], v[12:15]
    ds_read_b64_tr_b16 v[214:215], v227 offset:10240
    v_mfma_f32_16x16x32_bf16 v[16:19], v[220:223], v[136:139], v[16:19]
    ds_write_b128 v230, v[68:71] offset:2048
    v_mfma_f32_16x16x32_bf16 v[20:23], v[220:223], v[140:143], v[20:23]
    s_waitcnt lgkmcnt(8)
    v_mfma_f32_16x16x32_bf16 v[0:3], v[192:195], v[144:147], v[0:3]
    ds_read_b64_tr_b16 v[216:217], v226 offset:12288
    v_mfma_f32_16x16x32_bf16 v[4:7], v[192:195], v[148:151], v[4:7]
    ds_read_b64_tr_b16 v[218:219], v226 offset:14336
    v_mfma_f32_16x16x32_bf16 v[8:11], v[192:195], v[152:155], v[8:11]
    ds_read_b64_tr_b16 v[220:221], v227 offset:12288
    v_mfma_f32_16x16x32_bf16 v[12:15], v[196:199], v[144:147], v[12:15]
    ds_read_b64_tr_b16 v[222:223], v227 offset:14336
    v_mov_b32 v230, v231
    v_mfma_f32_16x16x32_bf16 v[16:19], v[196:199], v[148:151], v[16:19]
    s_add_u32 s58, s58, 1
    s_and_b32 s58, s58, 3
    v_mfma_f32_16x16x32_bf16 v[20:23], v[196:199], v[152:155], v[20:23]
    s_cmp_eq_u32 s58, 0
    s_cselect_b32 s56, s57, 35840
    s_waitcnt lgkmcnt(4)
    s_barrier
    v_add_u32 v224, s56, v224
    v_add_u32 v225, s56, v225
    v_mfma_f32_16x16x32_bf16 v[0:3], v[200:203], v[156:159], v[0:3]
    ds_read_b64_tr_b16 v[192:193], v224 offset:0
    v_mfma_f32_16x16x32_bf16 v[4:7], v[200:203], v[160:163], v[4:7]
    ds_read_b64_tr_b16 v[194:195], v224 offset:2048
    v_mfma_f32_16x16x32_bf16 v[8:11], v[200:203], v[164:167], v[8:11]
    ds_read_b64_tr_b16 v[196:197], v225 offset:0
    v_mfma_f32_16x16x32_bf16 v[12:15], v[204:207], v[156:159], v[12:15]
    ds_read_b64_tr_b16 v[198:199], v225 offset:2048
    v_mfma_f32_16x16x32_bf16 v[16:19], v[204:207], v[160:163], v[16:19]
    v_mfma_f32_16x16x32_bf16 v[20:23], v[204:207], v[164:167], v[20:23]
    s_waitcnt lgkmcnt(8)
    v_mfma_f32_16x16x32_bf16 v[0:3], v[208:211], v[168:171], v[0:3]
    ds_read_b64_tr_b16 v[200:201], v224 offset:4096
    v_mfma_f32_16x16x32_bf16 v[4:7], v[208:211], v[172:175], v[4:7]
    ds_read_b64_tr_b16 v[202:203], v224 offset:6144
    v_mfma_f32_16x16x32_bf16 v[8:11], v[208:211], v[176:179], v[8:11]
    ds_read_b64_tr_b16 v[204:205], v225 offset:4096
    v_mfma_f32_16x16x32_bf16 v[12:15], v[212:215], v[168:171], v[12:15]
    ds_read_b64_tr_b16 v[206:207], v225 offset:6144
    v_mfma_f32_16x16x32_bf16 v[16:19], v[212:215], v[172:175], v[16:19]
    s_mov_b32 s69, s56
    v_mfma_f32_16x16x32_bf16 v[20:23], v[212:215], v[176:179], v[20:23]
    s_waitcnt lgkmcnt(8)
    v_mfma_f32_16x16x32_bf16 v[0:3], v[216:219], v[180:183], v[0:3]
    ds_read_b64_tr_b16 v[208:209], v224 offset:8192
    v_mfma_f32_16x16x32_bf16 v[4:7], v[216:219], v[184:187], v[4:7]
    ds_read_b64_tr_b16 v[210:211], v224 offset:10240
    v_mfma_f32_16x16x32_bf16 v[8:11], v[216:219], v[188:191], v[8:11]
    ds_read_b64_tr_b16 v[212:213], v225 offset:8192
    v_mfma_f32_16x16x32_bf16 v[12:15], v[220:223], v[180:183], v[12:15]
    ds_read_b64_tr_b16 v[214:215], v225 offset:10240
    v_mfma_f32_16x16x32_bf16 v[16:19], v[220:223], v[184:187], v[16:19]
    v_mfma_f32_16x16x32_bf16 v[20:23], v[220:223], v[188:191], v[20:23]
    s_waitcnt lgkmcnt(8)
    v_mfma_f32_16x16x32_bf16 v[24:27], v[192:195], v[96:99], 0
    ds_read_b64_tr_b16 v[216:217], v224 offset:12288
    v_mfma_f32_16x16x32_bf16 v[28:31], v[192:195], v[100:103], 0
    ds_read_b64_tr_b16 v[218:219], v224 offset:14336
    v_mfma_f32_16x16x32_bf16 v[32:35], v[192:195], v[104:107], 0
    ds_read_b64_tr_b16 v[220:221], v225 offset:12288
    v_mfma_f32_16x16x32_bf16 v[36:39], v[196:199], v[96:99], 0
    ds_read_b64_tr_b16 v[222:223], v225 offset:14336
    v_mfma_f32_16x16x32_bf16 v[40:43], v[196:199], v[100:103], 0
    v_add_u32 v226, s69, v226
    v_mfma_f32_16x16x32_bf16 v[44:47], v[196:199], v[104:107], 0
    v_add_u32 v227, s69, v227
    s_waitcnt lgkmcnt(8)
    v_mfma_f32_16x16x32_bf16 v[24:27], v[200:203], v[108:111], v[24:27]
    ds_read_b64_tr_b16 v[192:193], v226 offset:0
    v_cvt_pk_bf16_f32 v48, v0, v1
    v_mfma_f32_16x16x32_bf16 v[28:31], v[200:203], v[112:115], v[28:31]
    ds_read_b64_tr_b16 v[194:195], v226 offset:2048
    v_cvt_pk_bf16_f32 v49, v2, v3
    v_mfma_f32_16x16x32_bf16 v[32:35], v[200:203], v[116:119], v[32:35]
    ds_read_b64_tr_b16 v[196:197], v227 offset:0
    v_cvt_pk_bf16_f32 v50, v12, v13
    v_mfma_f32_16x16x32_bf16 v[36:39], v[204:207], v[108:111], v[36:39]
    ds_read_b64_tr_b16 v[198:199], v227 offset:2048
    v_cvt_pk_bf16_f32 v51, v14, v15
    v_mfma_f32_16x16x32_bf16 v[40:43], v[204:207], v[112:115], v[40:43]
    v_cvt_pk_bf16_f32 v52, v4, v5
    v_mfma_f32_16x16x32_bf16 v[44:47], v[204:207], v[116:119], v[44:47]
    ds_write_b128 v229, v[48:51] offset:0
    s_waitcnt lgkmcnt(8)
    v_mfma_f32_16x16x32_bf16 v[24:27], v[208:211], v[120:123], v[24:27]
    ds_read_b64_tr_b16 v[200:201], v226 offset:4096
    v_cvt_pk_bf16_f32 v53, v6, v7
    v_mfma_f32_16x16x32_bf16 v[28:31], v[208:211], v[124:127], v[28:31]
    ds_read_b64_tr_b16 v[202:203], v226 offset:6144
    v_cvt_pk_bf16_f32 v54, v16, v17
    v_mfma_f32_16x16x32_bf16 v[32:35], v[208:211], v[128:131], v[32:35]
    ds_read_b64_tr_b16 v[204:205], v227 offset:4096
    v_cvt_pk_bf16_f32 v55, v18, v19
    v_mfma_f32_16x16x32_bf16 v[36:39], v[212:215], v[120:123], v[36:39]
    ds_read_b64_tr_b16 v[206:207], v227 offset:6144
    v_cvt_pk_bf16_f32 v56, v8, v9
    v_mfma_f32_16x16x32_bf16 v[40:43], v[212:215], v[124:127], v[40:43]
    v_mfma_f32_16x16x32_bf16 v[44:47], v[212:215], v[128:131], v[44:47]
    ds_write_b128 v229, v[52:55] offset:1024
    s_waitcnt lgkmcnt(8)
    v_mfma_f32_16x16x32_bf16 v[24:27], v[216:219], v[132:135], v[24:27]
    ds_read_b64_tr_b16 v[208:209], v226 offset:8192
    v_cvt_pk_bf16_f32 v57, v10, v11
    v_mfma_f32_16x16x32_bf16 v[28:31], v[216:219], v[136:139], v[28:31]
    ds_read_b64_tr_b16 v[210:211], v226 offset:10240
    v_cvt_pk_bf16_f32 v58, v20, v21
    v_mfma_f32_16x16x32_bf16 v[32:35], v[216:219], v[140:143], v[32:35]
    ds_read_b64_tr_b16 v[212:213], v227 offset:8192
    v_cvt_pk_bf16_f32 v59, v22, v23
    v_mfma_f32_16x16x32_bf16 v[36:39], v[220:223], v[132:135], v[36:39]
    ds_read_b64_tr_b16 v[214:215], v227 offset:10240
    v_mfma_f32_16x16x32_bf16 v[40:43], v[220:223], v[136:139], v[40:43]
    ds_write_b128 v229, v[56:59] offset:2048
    v_mfma_f32_16x16x32_bf16 v[44:47], v[220:223], v[140:143], v[44:47]
    s_waitcnt lgkmcnt(8)
    v_mfma_f32_16x16x32_bf16 v[24:27], v[192:195], v[144:147], v[24:27]
    ds_read_b64_tr_b16 v[216:217], v226 offset:12288
    v_mfma_f32_16x16x32_bf16 v[28:31], v[192:195], v[148:151], v[28:31]
    ds_read_b64_tr_b16 v[218:219], v226 offset:14336
    v_mfma_f32_16x16x32_bf16 v[32:35], v[192:195], v[152:155], v[32:35]
    ds_read_b64_tr_b16 v[220:221], v227 offset:12288
    v_mfma_f32_16x16x32_bf16 v[36:39], v[196:199], v[144:147], v[36:39]
    ds_read_b64_tr_b16 v[222:223], v227 offset:14336
    v_mfma_f32_16x16x32_bf16 v[40:43], v[196:199], v[148:151], v[40:43]
    s_add_u32 s58, s58, 1
    s_and_b32 s58, s58, 3
    v_mfma_f32_16x16x32_bf16 v[44:47], v[196:199], v[152:155], v[44:47]
    s_cmp_eq_u32 s58, 0
    s_cselect_b32 s56, s57, 35840
    s_waitcnt lgkmcnt(4)
    s_barrier
    v_add_u32 v224, s56, v224
    v_add_u32 v225, s56, v225
    v_mfma_f32_16x16x32_bf16 v[24:27], v[200:203], v[156:159], v[24:27]
    ds_read_b64_tr_b16 v[192:193], v224 offset:0
    v_mfma_f32_16x16x32_bf16 v[28:31], v[200:203], v[160:163], v[28:31]
    ds_read_b64_tr_b16 v[194:195], v224 offset:2048
    v_mfma_f32_16x16x32_bf16 v[32:35], v[200:203], v[164:167], v[32:35]
    ds_read_b64_tr_b16 v[196:197], v225 offset:0
    v_mfma_f32_16x16x32_bf16 v[36:39], v[204:207], v[156:159], v[36:39]
    ds_read_b64_tr_b16 v[198:199], v225 offset:2048
    v_mfma_f32_16x16x32_bf16 v[40:43], v[204:207], v[160:163], v[40:43]
    v_mfma_f32_16x16x32_bf16 v[44:47], v[204:207], v[164:167], v[44:47]
    s_waitcnt lgkmcnt(8)
    v_mfma_f32_16x16x32_bf16 v[24:27], v[208:211], v[168:171], v[24:27]
    ds_read_b64_tr_b16 v[200:201], v224 offset:4096
    v_mfma_f32_16x16x32_bf16 v[28:31], v[208:211], v[172:175], v[28:31]
    ds_read_b64_tr_b16 v[202:203], v224 offset:6144
    v_mfma_f32_16x16x32_bf16 v[32:35], v[208:211], v[176:179], v[32:35]
    ds_read_b64_tr_b16 v[204:205], v225 offset:4096
    v_mfma_f32_16x16x32_bf16 v[36:39], v[212:215], v[168:171], v[36:39]
    ds_read_b64_tr_b16 v[206:207], v225 offset:6144
    v_mfma_f32_16x16x32_bf16 v[40:43], v[212:215], v[172:175], v[40:43]
    s_mov_b32 s69, s56
    v_mfma_f32_16x16x32_bf16 v[44:47], v[212:215], v[176:179], v[44:47]
    s_waitcnt lgkmcnt(8)
    v_mfma_f32_16x16x32_bf16 v[24:27], v[216:219], v[180:183], v[24:27]
    ds_read_b64_tr_b16 v[208:209], v224 offset:8192
    v_mfma_f32_16x16x32_bf16 v[28:31], v[216:219], v[184:187], v[28:31]
    ds_read_b64_tr_b16 v[210:211], v224 offset:10240
    v_mfma_f32_16x16x32_bf16 v[32:35], v[216:219], v[188:191], v[32:35]
    ds_read_b64_tr_b16 v[212:213], v225 offset:8192
    v_mfma_f32_16x16x32_bf16 v[36:39], v[220:223], v[180:183], v[36:39]
    ds_read_b64_tr_b16 v[214:215], v225 offset:10240
    v_mfma_f32_16x16x32_bf16 v[40:43], v[220:223], v[184:187], v[40:43]
    v_mfma_f32_16x16x32_bf16 v[44:47], v[220:223], v[188:191], v[44:47]
    s_add_u32 s55, s55, 1
    s_cmp_lt_u32 s55, 4
    s_cbranch_scc1 Lo_64
    s_waitcnt lgkmcnt(8)
    v_mfma_f32_16x16x32_bf16 v[0:3], v[192:195], v[96:99], 0
    ds_read_b64_tr_b16 v[216:217], v224 offset:12288
    v_mfma_f32_16x16x32_bf16 v[4:7], v[192:195], v[100:103], 0
    ds_read_b64_tr_b16 v[218:219], v224 offset:14336
    v_mfma_f32_16x16x32_bf16 v[8:11], v[192:195], v[104:107], 0
    ds_read_b64_tr_b16 v[220:221], v225 offset:12288
    v_mfma_f32_16x16x32_bf16 v[12:15], v[196:199], v[96:99], 0
    ds_read_b64_tr_b16 v[222:223], v225 offset:14336
    v_mfma_f32_16x16x32_bf16 v[16:19], v[196:199], v[100:103], 0
    v_add_u32 v226, s69, v226
    v_mfma_f32_16x16x32_bf16 v[20:23], v[196:199], v[104:107], 0
    v_add_u32 v227, s69, v227
    s_waitcnt lgkmcnt(8)
    v_mfma_f32_16x16x32_bf16 v[0:3], v[200:203], v[108:111], v[0:3]
    ds_read_b64_tr_b16 v[192:193], v226 offset:0
    v_cvt_pk_bf16_f32 v60, v24, v25
    v_mfma_f32_16x16x32_bf16 v[4:7], v[200:203], v[112:115], v[4:7]
    ds_read_b64_tr_b16 v[194:195], v226 offset:2048
    v_cvt_pk_bf16_f32 v61, v26, v27
    v_mfma_f32_16x16x32_bf16 v[8:11], v[200:203], v[116:119], v[8:11]
    ds_read_b64_tr_b16 v[196:197], v227 offset:0
    v_cvt_pk_bf16_f32 v62, v36, v37
    v_mfma_f32_16x16x32_bf16 v[12:15], v[204:207], v[108:111], v[12:15]
    ds_read_b64_tr_b16 v[198:199], v227 offset:2048
    v_cvt_pk_bf16_f32 v63, v38, v39
    v_mfma_f32_16x16x32_bf16 v[16:19], v[204:207], v[112:115], v[16:19]
    v_cvt_pk_bf16_f32 v64, v28, v29
    v_mfma_f32_16x16x32_bf16 v[20:23], v[204:207], v[116:119], v[20:23]
    ds_write_b128 v230, v[60:63] offset:0
    s_waitcnt lgkmcnt(8)
    v_mfma_f32_16x16x32_bf16 v[0:3], v[208:211], v[120:123], v[0:3]
    ds_read_b64_tr_b16 v[200:201], v226 offset:4096
    v_cvt_pk_bf16_f32 v65, v30, v31
    v_mfma_f32_16x16x32_bf16 v[4:7], v[208:211], v[124:127], v[4:7]
    ds_read_b64_tr_b16 v[202:203], v226 offset:6144
    v_cvt_pk_bf16_f32 v66, v40, v41
    v_mfma_f32_16x16x32_bf16 v[8:11], v[208:211], v[128:131], v[8:11]
    ds_read_b64_tr_b16 v[204:205], v227 offset:4096
    v_cvt_pk_bf16_f32 v67, v42, v43
    v_mfma_f32_16x16x32_bf16 v[12:15], v[212:215], v[120:123], v[12:15]
    ds_read_b64_tr_b16 v[206:207], v227 offset:6144
    v_cvt_pk_bf16_f32 v68, v32, v33
    v_mfma_f32_16x16x32_bf16 v[16:19], v[212:215], v[124:127], v[16:19]
    v_mfma_f32_16x16x32_bf16 v[20:23], v[212:215], v[128:131], v[20:23]
    ds_write_b128 v230, v[64:67] offset:1024
    s_waitcnt lgkmcnt(8)
    v_mfma_f32_16x16x32_bf16 v[0:3], v[216:219], v[132:135], v[0:3]
    ds_read_b64_tr_b16 v[208:209], v226 offset:8192
    v_cvt_pk_bf16_f32 v69, v34, v35
    v_mfma_f32_16x16x32_bf16 v[4:7], v[216:219], v[136:139], v[4:7]
    ds_read_b64_tr_b16 v[210:211], v226 offset:10240
    v_cvt_pk_bf16_f32 v70, v44, v45
    v_mfma_f32_16x16x32_bf16 v[8:11], v[216:219], v[140:143], v[8:11]
    ds_read_b64_tr_b16 v[212:213], v227 offset:8192
    v_cvt_pk_bf16_f32 v71, v46, v47
    v_mfma_f32_16x16x32_bf16 v[12:15], v[220:223], v[132:135], v[12:15]
    ds_read_b64_tr_b16 v[214:215], v227 offset:10240
    v_mfma_f32_16x16x32_bf16 v[16:19], v[220:223], v[136:139], v[16:19]
    ds_write_b128 v230, v[68:71] offset:2048
    v_mfma_f32_16x16x32_bf16 v[20:23], v[220:223], v[140:143], v[20:23]
    s_waitcnt lgkmcnt(8)
    v_mfma_f32_16x16x32_bf16 v[0:3], v[192:195], v[144:147], v[0:3]
    ds_read_b64_tr_b16 v[216:217], v226 offset:12288
    v_mfma_f32_16x16x32_bf16 v[4:7], v[192:195], v[148:151], v[4:7]
    ds_read_b64_tr_b16 v[218:219], v226 offset:14336
    v_mfma_f32_16x16x32_bf16 v[8:11], v[192:195], v[152:155], v[8:11]
    ds_read_b64_tr_b16 v[220:221], v227 offset:12288
    v_mfma_f32_16x16x32_bf16 v[12:15], v[196:199], v[144:147], v[12:15]
    ds_read_b64_tr_b16 v[222:223], v227 offset:14336
    v_mov_b32 v230, v231
    v_mfma_f32_16x16x32_bf16 v[16:19], v[196:199], v[148:151], v[16:19]
    v_mfma_f32_16x16x32_bf16 v[20:23], v[196:199], v[152:155], v[20:23]
    s_waitcnt lgkmcnt(4)
    s_barrier
    v_mfma_f32_16x16x32_bf16 v[0:3], v[200:203], v[156:159], v[0:3]
    v_mfma_f32_16x16x32_bf16 v[4:7], v[200:203], v[160:163], v[4:7]
    v_mfma_f32_16x16x32_bf16 v[8:11], v[200:203], v[164:167], v[8:11]
    v_mfma_f32_16x16x32_bf16 v[12:15], v[204:207], v[156:159], v[12:15]
    v_mfma_f32_16x16x32_bf16 v[16:19], v[204:207], v[160:163], v[16:19]
    v_mfma_f32_16x16x32_bf16 v[20:23], v[204:207], v[164:167], v[20:23]
    s_waitcnt lgkmcnt(4)
    v_mfma_f32_16x16x32_bf16 v[0:3], v[208:211], v[168:171], v[0:3]
    v_mfma_f32_16x16x32_bf16 v[4:7], v[208:211], v[172:175], v[4:7]
    v_mfma_f32_16x16x32_bf16 v[8:11], v[208:211], v[176:179], v[8:11]
    v_mfma_f32_16x16x32_bf16 v[12:15], v[212:215], v[168:171], v[12:15]
    v_mfma_f32_16x16x32_bf16 v[16:19], v[212:215], v[172:175], v[16:19]
    v_mfma_f32_16x16x32_bf16 v[20:23], v[212:215], v[176:179], v[20:23]
    s_waitcnt lgkmcnt(0)
    v_mfma_f32_16x16x32_bf16 v[0:3], v[216:219], v[180:183], v[0:3]
    v_mfma_f32_16x16x32_bf16 v[4:7], v[216:219], v[184:187], v[4:7]
    v_mfma_f32_16x16x32_bf16 v[8:11], v[216:219], v[188:191], v[8:11]
    v_mfma_f32_16x16x32_bf16 v[12:15], v[220:223], v[180:183], v[12:15]
    v_mfma_f32_16x16x32_bf16 v[16:19], v[220:223], v[184:187], v[16:19]
    v_mfma_f32_16x16x32_bf16 v[20:23], v[220:223], v[188:191], v[20:23]
    s_nop 7
    v_cvt_pk_bf16_f32 v48, v0, v1
    v_cvt_pk_bf16_f32 v49, v2, v3
    v_cvt_pk_bf16_f32 v50, v12, v13
    v_cvt_pk_bf16_f32 v51, v14, v15
    ds_write_b128 v229, v[48:51] offset:0
    v_cvt_pk_bf16_f32 v52, v4, v5
    v_cvt_pk_bf16_f32 v53, v6, v7
    v_cvt_pk_bf16_f32 v54, v16, v17
    v_cvt_pk_bf16_f32 v55, v18, v19
    ds_write_b128 v229, v[52:55] offset:1024
    v_cvt_pk_bf16_f32 v56, v8, v9
    v_cvt_pk_bf16_f32 v57, v10, v11
    v_cvt_pk_bf16_f32 v58, v20, v21
    v_cvt_pk_bf16_f32 v59, v22, v23
    ds_write_b128 v229, v[56:59] offset:2048
    s_waitcnt lgkmcnt(0)
    s_barrier
    v_mov_b32 v1, v255
    s_mov_b32 s55, s44
    s_branch L_reduce
Lrare_24:
    v_subrev_u32 v253, s56, v247
    ds_read_b128 v[228:231], v253 offset:8704
    s_waitcnt lgkmcnt(0)
    v_mfma_f32_16x16x32_bf16 v[216:219], v[228:231], v[128:131], v[240:243]
    s_nop 3
    ds_read_b128 v[228:231], v253 offset:8768
    s_waitcnt lgkmcnt(0)
    v_mfma_f32_16x16x32_bf16 v[216:219], v[228:231], v[132:135], v[216:219]
    s_nop 3
    ds_read_b128 v[228:231], v253 offset:8832
    s_waitcnt lgkmcnt(0)
    v_mfma_f32_16x16x32_bf16 v[216:219], v[228:231], v[136:139], v[216:219]
    s_nop 3
    ds_read_b128 v[228:231], v253 offset:8896
    s_waitcnt lgkmcnt(0)
    v_mfma_f32_16x16x32_bf16 v[216:219], v[228:231], v[140:143], v[216:219]
    s_nop 3
    ds_read_b128 v[228:231], v253 offset:13056
    s_waitcnt lgkmcnt(0)
    v_mfma_f32_16x16x32_bf16 v[220:223], v[228:231], v[128:131], v[240:243]
    s_nop 3
    ds_read_b128 v[228:231], v253 offset:13120
    s_waitcnt lgkmcnt(0)
    v_mfma_f32_16x16x32_bf16 v[220:223], v[228:231], v[132:135], v[220:223]
    s_nop 3
    ds_read_b128 v[228:231], v253 offset:13184
    s_waitcnt lgkmcnt(0)
    v_mfma_f32_16x16x32_bf16 v[220:223], v[228:231], v[136:139], v[220:223]
    s_nop 3
    ds_read_b128 v[228:231], v253 offset:13248
    s_waitcnt lgkmcnt(0)
    v_mfma_f32_16x16x32_bf16 v[220:223], v[228:231], v[140:143], v[220:223]
    s_nop 3
    s_nop 7
    v_max3_f32 v252, v216, v217, v218
    v_max3_f32 v253, v219, v220, v221
    v_max3_f32 v252, v252, v222, v223
    v_max_f32 v252, v252, v253
    v_mov_b32 v253, v252
    s_nop 1
    v_permlane32_swap_b32 v252, v253
    v_max_f32 v252, v252, v253
    v_mov_b32 v253, v252
    s_nop 1
    v_permlane16_swap_b32 v252, v253
    v_max_f32 v252, v252, v253
    v_max_f32 v252, 0, v252
    v_sub_f32 v253, 0, v252
    v_exp_f32 v253, v253
    s_nop 0
    v_mul_f32 v246, v246, v253
    v_mul_f32 v64, v64, v253
    v_mul_f32 v65, v65, v253
    v_mul_f32 v66, v66, v253
    v_mul_f32 v67, v67, v253
    v_mul_f32 v68, v68, v253
    v_mul_f32 v69, v69, v253
    v_mul_f32 v70, v70, v253
    v_mul_f32 v71, v71, v253
    v_mul_f32 v72, v72, v253
    v_mul_f32 v73, v73, v253
    v_mul_f32 v74, v74, v253
    v_mul_f32 v75, v75, v253
    v_mul_f32 v76, v76, v253
    v_mul_f32 v77, v77, v253
    v_mul_f32 v78, v78, v253
    v_mul_f32 v79, v79, v253
    v_mul_f32 v80, v80, v253
    v_mul_f32 v81, v81, v253
    v_mul_f32 v82, v82, v253
    v_mul_f32 v83, v83, v253
    v_mul_f32 v84, v84, v253
    v_mul_f32 v85, v85, v253
    v_mul_f32 v86, v86, v253
    v_mul_f32 v87, v87, v253
    v_mul_f32 v88, v88, v253
    v_mul_f32 v89, v89, v253
    v_mul_f32 v90, v90, v253
    v_mul_f32 v91, v91, v253
    v_mul_f32 v92, v92, v253
    v_mul_f32 v93, v93, v253
    v_mul_f32 v94, v94, v253
    v_mul_f32 v95, v95, v253
    v_sub_f32 v240, v240, v252
    v_sub_f32 v241, v241, v252
    v_sub_f32 v242, v242, v252
    v_sub_f32 v243, v243, v252
    v_sub_f32 v216, v216, v252
    v_sub_f32 v217, v217, v252
    v_sub_f32 v218, v218, v252
    v_sub_f32 v219, v219, v252
    v_sub_f32 v220, v220, v252
    v_sub_f32 v221, v221, v252
    v_sub_f32 v222, v222, v252
    v_sub_f32 v223, v223, v252
    v_exp_f32 v216, v216
    v_exp_f32 v217, v217
    v_exp_f32 v218, v218
    v_exp_f32 v219, v219
    v_exp_f32 v220, v220
    v_exp_f32 v221, v221
    v_exp_f32 v222, v222
    v_exp_f32 v223, v223
    s_nop 0
    v_add_f32 v254, v216, v217
    v_add_f32 v254, v254, v218
    v_add_f32 v254, v254, v219
    v_add_f32 v254, v254, v220
    v_add_f32 v254, v254, v221
    v_add_f32 v254, v254, v222
    v_add_f32 v254, v254, v223
    v_cvt_pk_bf16_f32 v228, v216, v217
    v_cvt_pk_bf16_f32 v229, v218, v219
    v_cvt_pk_bf16_f32 v230, v220, v221
    v_cvt_pk_bf16_f32 v231, v222, v223
    s_nop 1
    s_branch Lcont_25
Lrare_26:
    v_mov_b32 v253, v247
    ds_read_b128 v[224:227], v253 offset:0
    s_waitcnt lgkmcnt(0)
    v_mfma_f32_16x16x32_bf16 v[208:211], v[224:227], v[96:99], v[232:235]
    s_nop 3
    ds_read_b128 v[224:227], v253 offset:64
    s_waitcnt lgkmcnt(0)
    v_mfma_f32_16x16x32_bf16 v[208:211], v[224:227], v[100:103], v[208:211]
    s_nop 3
    ds_read_b128 v[224:227], v253 offset:128
    s_waitcnt lgkmcnt(0)
    v_mfma_f32_16x16x32_bf16 v[208:211], v[224:227], v[104:107], v[208:211]
    s_nop 3
    ds_read_b128 v[224:227], v253 offset:192
    s_waitcnt lgkmcnt(0)
    v_mfma_f32_16x16x32_bf16 v[208:211], v[224:227], v[108:111], v[208:211]
    s_nop 3
    ds_read_b128 v[224:227], v253 offset:4352
    s_waitcnt lgkmcnt(0)
    v_mfma_f32_16x16x32_bf16 v[212:215], v[224:227], v[96:99], v[232:235]
    s_nop 3
    ds_read_b128 v[224:227], v253 offset:4416
    s_waitcnt lgkmcnt(0)
    v_mfma_f32_16x16x32_bf16 v[212:215], v[224:227], v[100:103], v[212:215]
    s_nop 3
    ds_read_b128 v[224:227], v253 offset:4480
    s_waitcnt lgkmcnt(0)
    v_mfma_f32_16x16x32_bf16 v[212:215], v[224:227], v[104:107], v[212:215]
    s_nop 3
    ds_read_b128 v[224:227], v253 offset:4544
    s_waitcnt lgkmcnt(0)
    v_mfma_f32_16x16x32_bf16 v[212:215], v[224:227], v[108:111], v[212:215]
    s_nop 3
    s_nop 7
    v_max3_f32 v252, v208, v209, v210
    v_max3_f32 v253, v211, v212, v213
    v_max3_f32 v252, v252, v214, v215
    v_max_f32 v252, v252, v253
    v_mov_b32 v253, v252
    s_nop 1
    v_permlane32_swap_b32 v252, v253
    v_max_f32 v252, v252, v253
    v_mov_b32 v253, v252
    s_nop 1
    v_permlane16_swap_b32 v252, v253
    v_max_f32 v252, v252, v253
    v_max_f32 v252, 0, v252
    v_sub_f32 v253, 0, v252
    v_exp_f32 v253, v253
    s_nop 0
    v_mul_f32 v244, v244, v253
    v_mul_f32 v0, v0, v253
    v_mul_f32 v1, v1, v253
    v_mul_f32 v2, v2, v253
    v_mul_f32 v3, v3, v253
    v_mul_f32 v4, v4, v253
    v_mul_f32 v5, v5, v253
    v_mul_f32 v6, v6, v253
    v_mul_f32 v7, v7, v253
    v_mul_f32 v8, v8, v253
    v_mul_f32 v9, v9, v253
    v_mul_f32 v10, v10, v253
    v_mul_f32 v11, v11, v253
    v_mul_f32 v12, v12, v253
    v_mul_f32 v13, v13, v253
    v_mul_f32 v14, v14, v253
    v_mul_f32 v15, v15, v253
    v_mul_f32 v16, v16, v253
    v_mul_f32 v17, v17, v253
    v_mul_f32 v18, v18, v253
    v_mul_f32 v19, v19, v253
    v_mul_f32 v20, v20, v253
    v_mul_f32 v21, v21, v253
    v_mul_f32 v22, v22, v253
    v_mul_f32 v23, v23, v253
    v_mul_f32 v24, v24, v253
    v_mul_f32 v25, v25, v253
    v_mul_f32 v26, v26, v253
    v_mul_f32 v27, v27, v253
    v_mul_f32 v28, v28, v253
    v_mul_f32 v29, v29, v253
    v_mul_f32 v30, v30, v253
    v_mul_f32 v31, v31, v253
    v_sub_f32 v232, v232, v252
    v_sub_f32 v233, v233, v252
    v_sub_f32 v234, v234, v252
    v_sub_f32 v235, v235, v252
    v_sub_f32 v208, v208, v252
    v_sub_f32 v209, v209, v252
    v_sub_f32 v210, v210, v252
    v_sub_f32 v211, v211, v252
    v_sub_f32 v212, v212, v252
    v_sub_f32 v213, v213, v252
    v_sub_f32 v214, v214, v252
    v_sub_f32 v215, v215, v252
    v_exp_f32 v208, v208
    v_exp_f32 v209, v209
    v_exp_f32 v210, v210
    v_exp_f32 v211, v211
    v_exp_f32 v212, v212
    v_exp_f32 v213, v213
    v_exp_f32 v214, v214
    v_exp_f32 v215, v215
    s_nop 0
    v_add_f32 v254, v208, v209
    v_add_f32 v254, v254, v210
    v_add_f32 v254, v254, v211
    v_add_f32 v254, v254, v212
    v_add_f32 v254, v254, v213
    v_add_f32 v254, v254, v214
    v_add_f32 v254, v254, v215
    v_cvt_pk_bf16_f32 v224, v208, v209
    v_cvt_pk_bf16_f32 v225, v210, v211
    v_cvt_pk_bf16_f32 v226, v212, v213
    v_cvt_pk_bf16_f32 v227, v214, v215
    s_nop 1
    s_branch Lcont_27
Lrare_28:
    v_mov_b32 v253, v247
    ds_read_b128 v[228:231], v253 offset:0
    s_waitcnt lgkmcnt(0)
    v_mfma_f32_16x16x32_bf16 v[216:219], v[228:231], v[112:115], v[236:239]
    s_nop 3
    ds_read_b128 v[228:231], v253 offset:64
    s_waitcnt lgkmcnt(0)
    v_mfma_f32_16x16x32_bf16 v[216:219], v[228:231], v[116:119], v[216:219]
    s_nop 3
    ds_read_b128 v[228:231], v253 offset:128
    s_waitcnt lgkmcnt(0)
    v_mfma_f32_16x16x32_bf16 v[216:219], v[228:231], v[120:123], v[216:219]
    s_nop 3
    ds_read_b128 v[228:231], v253 offset:192
    s_waitcnt lgkmcnt(0)
    v_mfma_f32_16x16x32_bf16 v[216:219], v[228:231], v[124:127], v[216:219]
    s_nop 3
    ds_read_b128 v[228:231], v253 offset:4352
    s_waitcnt lgkmcnt(0)
    v_mfma_f32_16x16x32_bf16 v[220:223], v[228:231], v[112:115], v[236:239]
    s_nop 3
    ds_read_b128 v[228:231], v253 offset:4416
    s_waitcnt lgkmcnt(0)
    v_mfma_f32_16x16x32_bf16 v[220:223], v[228:231], v[116:119], v[220:223]
    s_nop 3
    ds_read_b128 v[228:231], v253 offset:4480
    s_waitcnt lgkmcnt(0)
    v_mfma_f32_16x16x32_bf16 v[220:223], v[228:231], v[120:123], v[220:223]
    s_nop 3
    ds_read_b128 v[228:231], v253 offset:4544
    s_waitcnt lgkmcnt(0)
    v_mfma_f32_16x16x32_bf16 v[220:223], v[228:231], v[124:127], v[220:223]
    s_nop 3
    s_nop 7
    v_max3_f32 v252, v216, v217, v218
    v_max3_f32 v253, v219, v220, v221
    v_max3_f32 v252, v252, v222, v223
    v_max_f32 v252, v252, v253
    v_mov_b32 v253, v252
    s_nop 1
    v_permlane32_swap_b32 v252, v253
    v_max_f32 v252, v252, v253
    v_mov_b32 v253, v252
    s_nop 1
    v_permlane16_swap_b32 v252, v253
    v_max_f32 v252, v252, v253
    v_max_f32 v252, 0, v252
    v_sub_f32 v253, 0, v252
    v_exp_f32 v253, v253
    s_nop 0
    v_mul_f32 v245, v245, v253
    v_mul_f32 v32, v32, v253
    v_mul_f32 v33, v33, v253
    v_mul_f32 v34, v34, v253
    v_mul_f32 v35, v35, v253
    v_mul_f32 v36, v36, v253
    v_mul_f32 v37, v37, v253
    v_mul_f32 v38, v38, v253
    v_mul_f32 v39, v39, v253
    v_mul_f32 v40, v40, v253
    v_mul_f32 v41, v41, v253
    v_mul_f32 v42, v42, v253
    v_mul_f32 v43, v43, v253
    v_mul_f32 v44, v44, v253
    v_mul_f32 v45, v45, v253
    v_mul_f32 v46, v46, v253
    v_mul_f32 v47, v47, v253
    v_mul_f32 v48, v48, v253
    v_mul_f32 v49, v49, v253
    v_mul_f32 v50, v50, v253
    v_mul_f32 v51, v51, v253
    v_mul_f32 v52, v52, v253
    v_mul_f32 v53, v53, v253
    v_mul_f32 v54, v54, v253
    v_mul_f32 v55, v55, v253
    v_mul_f32 v56, v56, v253
    v_mul_f32 v57, v57, v253
    v_mul_f32 v58, v58, v253
    v_mul_f32 v59, v59, v253
    v_mul_f32 v60, v60, v253
    v_mul_f32 v61, v61, v253
    v_mul_f32 v62, v62, v253
    v_mul_f32 v63, v63, v253
    v_sub_f32 v236, v236, v252
    v_sub_f32 v237, v237, v252
    v_sub_f32 v238, v238, v252
    v_sub_f32 v239, v239, v252
    v_sub_f32 v216, v216, v252
    v_sub_f32 v217, v217, v252
    v_sub_f32 v218, v218, v252
    v_sub_f32 v219, v219, v252
    v_sub_f32 v220, v220, v252
    v_sub_f32 v221, v221, v252
    v_sub_f32 v222, v222, v252
    v_sub_f32 v223, v223, v252
    v_exp_f32 v216, v216
    v_exp_f32 v217, v217
    v_exp_f32 v218, v218
    v_exp_f32 v219, v219
    v_exp_f32 v220, v220
    v_exp_f32 v221, v221
    v_exp_f32 v222, v222
    v_exp_f32 v223, v223
    s_nop 0
    v_add_f32 v254, v216, v217
    v_add_f32 v254, v254, v218
    v_add_f32 v254, v254, v219
    v_add_f32 v254, v254, v220
    v_add_f32 v254, v254, v221
    v_add_f32 v254, v254, v222
    v_add_f32 v254, v254, v223
    v_cvt_pk_bf16_f32 v228, v216, v217
    v_cvt_pk_bf16_f32 v229, v218, v219
    v_cvt_pk_bf16_f32 v230, v220, v221
    v_cvt_pk_bf16_f32 v231, v222, v223
    s_nop 1
    s_branch Lcont_29
Lrare_30:
    v_mov_b32 v253, v247
    ds_read_b128 v[224:227], v253 offset:0
    s_waitcnt lgkmcnt(0)
    v_mfma_f32_16x16x32_bf16 v[208:211], v[224:227], v[128:131], v[240:243]
    s_nop 3
    ds_read_b128 v[224:227], v253 offset:64
    s_waitcnt lgkmcnt(0)
    v_mfma_f32_16x16x32_bf16 v[208:211], v[224:227], v[132:135], v[208:211]
    s_nop 3
    ds_read_b128 v[224:227], v253 offset:128
    s_waitcnt lgkmcnt(0)
    v_mfma_f32_16x16x32_bf16 v[208:211], v[224:227], v[136:139], v[208:211]
    s_nop 3
    ds_read_b128 v[224:227], v253 offset:192
    s_waitcnt lgkmcnt(0)
    v_mfma_f32_16x16x32_bf16 v[208:211], v[224:227], v[140:143], v[208:211]
    s_nop 3
    ds_read_b128 v[224:227], v253 offset:4352
    s_waitcnt lgkmcnt(0)
    v_mfma_f32_16x16x32_bf16 v[212:215], v[224:227], v[128:131], v[240:243]
    s_nop 3
    ds_read_b128 v[224:227], v253 offset:4416
    s_waitcnt lgkmcnt(0)
    v_mfma_f32_16x16x32_bf16 v[212:215], v[224:227], v[132:135], v[212:215]
    s_nop 3
    ds_read_b128 v[224:227], v253 offset:4480
    s_waitcnt lgkmcnt(0)
    v_mfma_f32_16x16x32_bf16 v[212:215], v[224:227], v[136:139], v[212:215]
    s_nop 3
    ds_read_b128 v[224:227], v253 offset:4544
    s_waitcnt lgkmcnt(0)
    v_mfma_f32_16x16x32_bf16 v[212:215], v[224:227], v[140:143], v[212:215]
    s_nop 3
    s_nop 7
    v_max3_f32 v252, v208, v209, v210
    v_max3_f32 v253, v211, v212, v213
    v_max3_f32 v252, v252, v214, v215
    v_max_f32 v252, v252, v253
    v_mov_b32 v253, v252
    s_nop 1
    v_permlane32_swap_b32 v252, v253
    v_max_f32 v252, v252, v253
    v_mov_b32 v253, v252
    s_nop 1
    v_permlane16_swap_b32 v252, v253
    v_max_f32 v252, v252, v253
    v_max_f32 v252, 0, v252
    v_sub_f32 v253, 0, v252
    v_exp_f32 v253, v253
    s_nop 0
    v_mul_f32 v246, v246, v253
    v_mul_f32 v64, v64, v253
    v_mul_f32 v65, v65, v253
    v_mul_f32 v66, v66, v253
    v_mul_f32 v67, v67, v253
    v_mul_f32 v68, v68, v253
    v_mul_f32 v69, v69, v253
    v_mul_f32 v70, v70, v253
    v_mul_f32 v71, v71, v253
    v_mul_f32 v72, v72, v253
    v_mul_f32 v73, v73, v253
    v_mul_f32 v74, v74, v253
    v_mul_f32 v75, v75, v253
    v_mul_f32 v76, v76, v253
    v_mul_f32 v77, v77, v253
    v_mul_f32 v78, v78, v253
    v_mul_f32 v79, v79, v253
    v_mul_f32 v80, v80, v253
    v_mul_f32 v81, v81, v253
    v_mul_f32 v82, v82, v253
    v_mul_f32 v83, v83, v253
    v_mul_f32 v84, v84, v253
    v_mul_f32 v85, v85, v253
    v_mul_f32 v86, v86, v253
    v_mul_f32 v87, v87, v253
    v_mul_f32 v88, v88, v253
    v_mul_f32 v89, v89, v253
    v_mul_f32 v90, v90, v253
    v_mul_f32 v91, v91, v253
    v_mul_f32 v92, v92, v253
    v_mul_f32 v93, v93, v253
    v_mul_f32 v94, v94, v253
    v_mul_f32 v95, v95, v253
    v_sub_f32 v240, v240, v252
    v_sub_f32 v241, v241, v252
    v_sub_f32 v242, v242, v252
    v_sub_f32 v243, v243, v252
    v_sub_f32 v208, v208, v252
    v_sub_f32 v209, v209, v252
    v_sub_f32 v210, v210, v252
    v_sub_f32 v211, v211, v252
    v_sub_f32 v212, v212, v252
    v_sub_f32 v213, v213, v252
    v_sub_f32 v214, v214, v252
    v_sub_f32 v215, v215, v252
    v_exp_f32 v208, v208
    v_exp_f32 v209, v209
    v_exp_f32 v210, v210
    v_exp_f32 v211, v211
    v_exp_f32 v212, v212
    v_exp_f32 v213, v213
    v_exp_f32 v214, v214
    v_exp_f32 v215, v215
    s_nop 0
    v_add_f32 v254, v208, v209
    v_add_f32 v254, v254, v210
    v_add_f32 v254, v254, v211
    v_add_f32 v254, v254, v212
    v_add_f32 v254, v254, v213
    v_add_f32 v254, v254, v214
    v_add_f32 v254, v254, v215
    v_cvt_pk_bf16_f32 v224, v208, v209
    v_cvt_pk_bf16_f32 v225, v210, v211
    v_cvt_pk_bf16_f32 v226, v212, v213
    v_cvt_pk_bf16_f32 v227, v214, v215
    s_nop 1
    s_branch Lcont_31
Lrare_32:
    v_mov_b32 v253, v247
    ds_read_b128 v[228:231], v253 offset:8704
    s_waitcnt lgkmcnt(0)
    v_mfma_f32_16x16x32_bf16 v[216:219], v[228:231], v[96:99], v[232:235]
    s_nop 3
    ds_read_b128 v[228:231], v253 offset:8768
    s_waitcnt lgkmcnt(0)
    v_mfma_f32_16x16x32_bf16 v[216:219], v[228:231], v[100:103], v[216:219]
    s_nop 3
    ds_read_b128 v[228:231], v253 offset:8832
    s_waitcnt lgkmcnt(0)
    v_mfma_f32_16x16x32_bf16 v[216:219], v[228:231], v[104:107], v[216:219]
    s_nop 3
    ds_read_b128 v[228:231], v253 offset:8896
    s_waitcnt lgkmcnt(0)
    v_mfma_f32_16x16x32_bf16 v[216:219], v[228:231], v[108:111], v[216:219]
    s_nop 3
    ds_read_b128 v[228:231], v253 offset:13056
    s_waitcnt lgkmcnt(0)
    v_mfma_f32_16x16x32_bf16 v[220:223], v[228:231], v[96:99], v[232:235]
    s_nop 3
    ds_read_b128 v[228:231], v253 offset:13120
    s_waitcnt lgkmcnt(0)
    v_mfma_f32_16x16x32_bf16 v[220:223], v[228:231], v[100:103], v[220:223]
    s_nop 3
    ds_read_b128 v[228:231], v253 offset:13184
    s_waitcnt lgkmcnt(0)
    v_mfma_f32_16x16x32_bf16 v[220:223], v[228:231], v[104:107], v[220:223]
    s_nop 3
    ds_read_b128 v[228:231], v253 offset:13248
    s_waitcnt lgkmcnt(0)
    v_mfma_f32_16x16x32_bf16 v[220:223], v[228:231], v[108:111], v[220:223]
    s_nop 3
    s_nop 7
    v_max3_f32 v252, v216, v217, v218
    v_max3_f32 v253, v219, v220, v221
    v_max3_f32 v252, v252, v222, v223
    v_max_f32 v252, v252, v253
    v_mov_b32 v253, v252
    s_nop 1
    v_permlane32_swap_b32 v252, v253
    v_max_f32 v252, v252, v253
    v_mov_b32 v253, v252
    s_nop 1
    v_permlane16_swap_b32 v252, v253
    v_max_f32 v252, v252, v253
    v_max_f32 v252, 0, v252
    v_sub_f32 v253, 0, v252
    v_exp_f32 v253, v253
    s_nop 0
    v_mul_f32 v244, v244, v253
    v_mul_f32 v0, v0, v253
    v_mul_f32 v1, v1, v253
    v_mul_f32 v2, v2, v253
    v_mul_f32 v3, v3, v253
    v_mul_f32 v4, v4, v253
    v_mul_f32 v5, v5, v253
    v_mul_f32 v6, v6, v253
    v_mul_f32 v7, v7, v253
    v_mul_f32 v8, v8, v253
    v_mul_f32 v9, v9, v253
    v_mul_f32 v10, v10, v253
    v_mul_f32 v11, v11, v253
    v_mul_f32 v12, v12, v253
    v_mul_f32 v13, v13, v253
    v_mul_f32 v14, v14, v253
    v_mul_f32 v15, v15, v253
    v_mul_f32 v16, v16, v253
    v_mul_f32 v17, v17, v253
    v_mul_f32 v18, v18, v253
    v_mul_f32 v19, v19, v253
    v_mul_f32 v20, v20, v253
    v_mul_f32 v21, v21, v253
    v_mul_f32 v22, v22, v253
    v_mul_f32 v23, v23, v253
    v_mul_f32 v24, v24, v253
    v_mul_f32 v25, v25, v253
    v_mul_f32 v26, v26, v253
    v_mul_f32 v27, v27, v253
    v_mul_f32 v28, v28, v253
    v_mul_f32 v29, v29, v253
    v_mul_f32 v30, v30, v253
    v_mul_f32 v31, v31, v253
    v_sub_f32 v232, v232, v252
    v_sub_f32 v233, v233, v252
    v_sub_f32 v234, v234, v252
    v_sub_f32 v235, v235, v252
    v_sub_f32 v216, v216, v252
    v_sub_f32 v217, v217, v252
    v_sub_f32 v218, v218, v252
    v_sub_f32 v219, v219, v252
    v_sub_f32 v220, v220, v252
    v_sub_f32 v221, v221, v252
    v_sub_f32 v222, v222, v252
    v_sub_f32 v223, v223, v252
    v_exp_f32 v216, v216
    v_exp_f32 v217, v217
    v_exp_f32 v218, v218
    v_exp_f32 v219, v219
    v_exp_f32 v220, v220
    v_exp_f32 v221, v221
    v_exp_f32 v222, v222
    v_exp_f32 v223, v223
    s_nop 0
    v_add_f32 v254, v216, v217
    v_add_f32 v254, v254, v218
    v_add_f32 v254, v254, v219
    v_add_f32 v254, v254, v220
    v_add_f32 v254, v254, v221
    v_add_f32 v254, v254, v222
    v_add_f32 v254, v254, v223
    v_cvt_pk_bf16_f32 v228, v216, v217
    v_cvt_pk_bf16_f32 v229, v218, v219
    v_cvt_pk_bf16_f32 v230, v220, v221
    v_cvt_pk_bf16_f32 v231, v222, v223
    s_nop 1
    s_branch Lcont_33
Lrare_34:
    v_subrev_u32 v253, s56, v247
    ds_read_b128 v[224:227], v253 offset:8704
    s_waitcnt lgkmcnt(0)
    v_mfma_f32_16x16x32_bf16 v[208:211], v[224:227], v[112:115], v[236:239]
    s_nop 3
    ds_read_b128 v[224:227], v253 offset:8768
    s_waitcnt lgkmcnt(0)
    v_mfma_f32_16x16x32_bf16 v[208:211], v[224:227], v[116:119], v[208:211]
    s_nop 3
    ds_read_b128 v[224:227], v253 offset:8832
    s_waitcnt lgkmcnt(0)
    v_mfma_f32_16x16x32_bf16 v[208:211], v[224:227], v[120:123], v[208:211]
    s_nop 3
    ds_read_b128 v[224:227], v253 offset:8896
    s_waitcnt lgkmcnt(0)
    v_mfma_f32_16x16x32_bf16 v[208:211], v[224:227], v[124:127], v[208:211]
    s_nop 3
    ds_read_b128 v[224:227], v253 offset:13056
    s_waitcnt lgkmcnt(0)
    v_mfma_f32_16x16x32_bf16 v[212:215], v[224:227], v[112:115], v[236:239]
    s_nop 3
    ds_read_b128 v[224:227], v253 offset:13120
    s_waitcnt lgkmcnt(0)
    v_mfma_f32_16x16x32_bf16 v[212:215], v[224:227], v[116:119], v[212:215]
    s_nop 3
    ds_read_b128 v[224:227], v253 offset:13184
    s_waitcnt lgkmcnt(0)
    v_mfma_f32_16x16x32_bf16 v[212:215], v[224:227], v[120:123], v[212:215]
    s_nop 3
    ds_read_b128 v[224:227], v253 offset:13248
    s_waitcnt lgkmcnt(0)
    v_mfma_f32_16x16x32_bf16 v[212:215], v[224:227], v[124:127], v[212:215]
    s_nop 3
    s_nop 7
    v_max3_f32 v252, v208, v209, v210
    v_max3_f32 v253, v211, v212, v213
    v_max3_f32 v252, v252, v214, v215
    v_max_f32 v252, v252, v253
    v_mov_b32 v253, v252
    s_nop 1
    v_permlane32_swap_b32 v252, v253
    v_max_f32 v252, v252, v253
    v_mov_b32 v253, v252
    s_nop 1
    v_permlane16_swap_b32 v252, v253
    v_max_f32 v252, v252, v253
    v_max_f32 v252, 0, v252
    v_sub_f32 v253, 0, v252
    v_exp_f32 v253, v253
    s_nop 0
    v_mul_f32 v245, v245, v253
    v_mul_f32 v32, v32, v253
    v_mul_f32 v33, v33, v253
    v_mul_f32 v34, v34, v253
    v_mul_f32 v35, v35, v253
    v_mul_f32 v36, v36, v253
    v_mul_f32 v37, v37, v253
    v_mul_f32 v38, v38, v253
    v_mul_f32 v39, v39, v253
    v_mul_f32 v40, v40, v253
    v_mul_f32 v41, v41, v253
    v_mul_f32 v42, v42, v253
    v_mul_f32 v43, v43, v253
    v_mul_f32 v44, v44, v253
    v_mul_f32 v45, v45, v253
    v_mul_f32 v46, v46, v253
    v_mul_f32 v47, v47, v253
    v_mul_f32 v48, v48, v253
    v_mul_f32 v49, v49, v253
    v_mul_f32 v50, v50, v253
    v_mul_f32 v51, v51, v253
    v_mul_f32 v52, v52, v253
    v_mul_f32 v53, v53, v253
    v_mul_f32 v54, v54, v253
    v_mul_f32 v55, v55, v253
    v_mul_f32 v56, v56, v253
    v_mul_f32 v57, v57, v253
    v_mul_f32 v58, v58, v253
    v_mul_f32 v59, v59, v253
    v_mul_f32 v60, v60, v253
    v_mul_f32 v61, v61, v253
    v_mul_f32 v62, v62, v253
    v_mul_f32 v63, v63, v253
    v_sub_f32 v236, v236, v252
    v_sub_f32 v237, v237, v252
    v_sub_f32 v238, v238, v252
    v_sub_f32 v239, v239, v252
    v_sub_f32 v208, v208, v252
    v_sub_f32 v209, v209, v252
    v_sub_f32 v210, v210, v252
    v_sub_f32 v211, v211, v252
    v_sub_f32 v212, v212, v252
    v_sub_f32 v213, v213, v252
    v_sub_f32 v214, v214, v252
    v_sub_f32 v215, v215, v252
    v_exp_f32 v208, v208
    v_exp_f32 v209, v209
    v_exp_f32 v210, v210
    v_exp_f32 v211, v211
    v_exp_f32 v212, v212
    v_exp_f32 v213, v213
    v_exp_f32 v214, v214
    v_exp_f32 v215, v215
    s_nop 0
    v_add_f32 v254, v208, v209
    v_add_f32 v254, v254, v210
    v_add_f32 v254, v254, v211
    v_add_f32 v254, v254, v212
    v_add_f32 v254, v254, v213
    v_add_f32 v254, v254, v214
    v_add_f32 v254, v254, v215
    v_cvt_pk_bf16_f32 v224, v208, v209
    v_cvt_pk_bf16_f32 v225, v210, v211
    v_cvt_pk_bf16_f32 v226, v212, v213
    v_cvt_pk_bf16_f32 v227, v214, v215
    s_nop 1
    s_branch Lcont_35
Lrare_49:
    v_subrev_u32 v253, s56, v247
    ds_read_b128 v[228:231], v253 offset:8704
    s_waitcnt lgkmcnt(0)
    v_mfma_f32_16x16x32_bf16 v[216:219], v[228:231], v[128:131], v[240:243]
    s_nop 3
    ds_read_b128 v[228:231], v253 offset:8768
    s_waitcnt lgkmcnt(0)
    v_mfma_f32_16x16x32_bf16 v[216:219], v[228:231], v[132:135], v[216:219]
    s_nop 3
    ds_read_b128 v[228:231], v253 offset:8832
    s_waitcnt lgkmcnt(0)
    v_mfma_f32_16x16x32_bf16 v[216:219], v[228:231], v[136:139], v[216:219]
    s_nop 3
    ds_read_b128 v[228:231], v253 offset:8896
    s_waitcnt lgkmcnt(0)
    v_mfma_f32_16x16x32_bf16 v[216:219], v[228:231], v[140:143], v[216:219]
    s_nop 3
    ds_read_b128 v[228:231], v253 offset:13056
    s_waitcnt lgkmcnt(0)
    v_mfma_f32_16x16x32_bf16 v[220:223], v[228:231], v[128:131], v[240:243]
    s_nop 3
    ds_read_b128 v[228:231], v253 offset:13120
    s_waitcnt lgkmcnt(0)
    v_mfma_f32_16x16x32_bf16 v[220:223], v[228:231], v[132:135], v[220:223]
    s_nop 3
    ds_read_b128 v[228:231], v253 offset:13184
    s_waitcnt lgkmcnt(0)
    v_mfma_f32_16x16x32_bf16 v[220:223], v[228:231], v[136:139], v[220:223]
    s_nop 3
    ds_read_b128 v[228:231], v253 offset:13248
    s_waitcnt lgkmcnt(0)
    v_mfma_f32_16x16x32_bf16 v[220:223], v[228:231], v[140:143], v[220:223]
    s_nop 3
    s_nop 7
    v_max3_f32 v252, v216, v217, v218
    v_max3_f32 v253, v219, v220, v221
    v_max3_f32 v252, v252, v222, v223
    v_max_f32 v252, v252, v253
    v_mov_b32 v253, v252
    s_nop 1
    v_permlane32_swap_b32 v252, v253
    v_max_f32 v252, v252, v253
    v_mov_b32 v253, v252
    s_nop 1
    v_permlane16_swap_b32 v252, v253
    v_max_f32 v252, v252, v253
    v_max_f32 v252, 0, v252
    v_sub_f32 v253, 0, v252
    v_exp_f32 v253, v253
    s_nop 0
    v_mul_f32 v246, v246, v253
    v_mul_f32 v64, v64, v253
    v_mul_f32 v65, v65, v253
    v_mul_f32 v66, v66, v253
    v_mul_f32 v67, v67, v253
    v_mul_f32 v68, v68, v253
    v_mul_f32 v69, v69, v253
    v_mul_f32 v70, v70, v253
    v_mul_f32 v71, v71, v253
    v_mul_f32 v72, v72, v253
    v_mul_f32 v73, v73, v253
    v_mul_f32 v74, v74, v253
    v_mul_f32 v75, v75, v253
    v_mul_f32 v76, v76, v253
    v_mul_f32 v77, v77, v253
    v_mul_f32 v78, v78, v253
    v_mul_f32 v79, v79, v253
    v_mul_f32 v80, v80, v253
    v_mul_f32 v81, v81, v253
    v_mul_f32 v82, v82, v253
    v_mul_f32 v83, v83, v253
    v_mul_f32 v84, v84, v253
    v_mul_f32 v85, v85, v253
    v_mul_f32 v86, v86, v253
    v_mul_f32 v87, v87, v253
    v_mul_f32 v88, v88, v253
    v_mul_f32 v89, v89, v253
    v_mul_f32 v90, v90, v253
    v_mul_f32 v91, v91, v253
    v_mul_f32 v92, v92, v253
    v_mul_f32 v93, v93, v253
    v_mul_f32 v94, v94, v253
    v_mul_f32 v95, v95, v253
    v_sub_f32 v240, v240, v252
    v_sub_f32 v241, v241, v252
    v_sub_f32 v242, v242, v252
    v_sub_f32 v243, v243, v252
    v_sub_f32 v216, v216, v252
    v_sub_f32 v217, v217, v252
    v_sub_f32 v218, v218, v252
    v_sub_f32 v219, v219, v252
    v_sub_f32 v220, v220, v252
    v_sub_f32 v221, v221, v252
    v_sub_f32 v222, v222, v252
    v_sub_f32 v223, v223, v252
    v_exp_f32 v216, v216
    v_exp_f32 v217, v217
    v_exp_f32 v218, v218
    v_exp_f32 v219, v219
    v_exp_f32 v220, v220
    v_exp_f32 v221, v221
    v_exp_f32 v222, v222
    v_exp_f32 v223, v223
    s_nop 0
    v_add_f32 v254, v216, v217
    v_add_f32 v254, v254, v218
    v_add_f32 v254, v254, v219
    v_add_f32 v254, v254, v220
    v_add_f32 v254, v254, v221
    v_add_f32 v254, v254, v222
    v_add_f32 v254, v254, v223
    v_cvt_pk_bf16_f32 v228, v216, v217
    v_cvt_pk_bf16_f32 v229, v218, v219
    v_cvt_pk_bf16_f32 v230, v220, v221
    v_cvt_pk_bf16_f32 v231, v222, v223
    s_nop 1
    s_branch Lcont_50
Lrare_51:
    v_mov_b32 v253, v247
    ds_read_b128 v[224:227], v253 offset:0
    s_waitcnt lgkmcnt(0)
    v_mfma_f32_16x16x32_bf16 v[208:211], v[224:227], v[96:99], v[232:235]
    s_nop 3
    ds_read_b128 v[224:227], v253 offset:64
    s_waitcnt lgkmcnt(0)
    v_mfma_f32_16x16x32_bf16 v[208:211], v[224:227], v[100:103], v[208:211]
    s_nop 3
    ds_read_b128 v[224:227], v253 offset:128
    s_waitcnt lgkmcnt(0)
    v_mfma_f32_16x16x32_bf16 v[208:211], v[224:227], v[104:107], v[208:211]
    s_nop 3
    ds_read_b128 v[224:227], v253 offset:192
    s_waitcnt lgkmcnt(0)
    v_mfma_f32_16x16x32_bf16 v[208:211], v[224:227], v[108:111], v[208:211]
    s_nop 3
    ds_read_b128 v[224:227], v253 offset:4352
    s_waitcnt lgkmcnt(0)
    v_mfma_f32_16x16x32_bf16 v[212:215], v[224:227], v[96:99], v[232:235]
    s_nop 3
    ds_read_b128 v[224:227], v253 offset:4416
    s_waitcnt lgkmcnt(0)
    v_mfma_f32_16x16x32_bf16 v[212:215], v[224:227], v[100:103], v[212:215]
    s_nop 3
    ds_read_b128 v[224:227], v253 offset:4480
    s_waitcnt lgkmcnt(0)
    v_mfma_f32_16x16x32_bf16 v[212:215], v[224:227], v[104:107], v[212:215]
    s_nop 3
    ds_read_b128 v[224:227], v253 offset:4544
    s_waitcnt lgkmcnt(0)
    v_mfma_f32_16x16x32_bf16 v[212:215], v[224:227], v[108:111], v[212:215]
    s_nop 3
    s_nop 7
    v_max3_f32 v252, v208, v209, v210
    v_max3_f32 v253, v211, v212, v213
    v_max3_f32 v252, v252, v214, v215
    v_max_f32 v252, v252, v253
    v_mov_b32 v253, v252
    s_nop 1
    v_permlane32_swap_b32 v252, v253
    v_max_f32 v252, v252, v253
    v_mov_b32 v253, v252
    s_nop 1
    v_permlane16_swap_b32 v252, v253
    v_max_f32 v252, v252, v253
    v_max_f32 v252, 0, v252
    v_sub_f32 v253, 0, v252
    v_exp_f32 v253, v253
    s_nop 0
    v_mul_f32 v244, v244, v253
    v_mul_f32 v0, v0, v253
    v_mul_f32 v1, v1, v253
    v_mul_f32 v2, v2, v253
    v_mul_f32 v3, v3, v253
    v_mul_f32 v4, v4, v253
    v_mul_f32 v5, v5, v253
    v_mul_f32 v6, v6, v253
    v_mul_f32 v7, v7, v253
    v_mul_f32 v8, v8, v253
    v_mul_f32 v9, v9, v253
    v_mul_f32 v10, v10, v253
    v_mul_f32 v11, v11, v253
    v_mul_f32 v12, v12, v253
    v_mul_f32 v13, v13, v253
    v_mul_f32 v14, v14, v253
    v_mul_f32 v15, v15, v253
    v_mul_f32 v16, v16, v253
    v_mul_f32 v17, v17, v253
    v_mul_f32 v18, v18, v253
    v_mul_f32 v19, v19, v253
    v_mul_f32 v20, v20, v253
    v_mul_f32 v21, v21, v253
    v_mul_f32 v22, v22, v253
    v_mul_f32 v23, v23, v253
    v_mul_f32 v24, v24, v253
    v_mul_f32 v25, v25, v253
    v_mul_f32 v26, v26, v253
    v_mul_f32 v27, v27, v253
    v_mul_f32 v28, v28, v253
    v_mul_f32 v29, v29, v253
    v_mul_f32 v30, v30, v253
    v_mul_f32 v31, v31, v253
    v_sub_f32 v232, v232, v252
    v_sub_f32 v233, v233, v252
    v_sub_f32 v234, v234, v252
    v_sub_f32 v235, v235, v252
    v_sub_f32 v208, v208, v252
    v_sub_f32 v209, v209, v252
    v_sub_f32 v210, v210, v252
    v_sub_f32 v211, v211, v252
    v_sub_f32 v212, v212, v252
    v_sub_f32 v213, v213, v252
    v_sub_f32 v214, v214, v252
    v_sub_f32 v215, v215, v252
    v_exp_f32 v208, v208
    v_exp_f32 v209, v209
    v_exp_f32 v210, v210
    v_exp_f32 v211, v211
    v_exp_f32 v212, v212
    v_exp_f32 v213, v213
    v_exp_f32 v214, v214
    v_exp_f32 v215, v215
    s_nop 0
    v_add_f32 v254, v208, v209
    v_add_f32 v254, v254, v210
    v_add_f32 v254, v254, v211
    v_add_f32 v254, v254, v212
    v_add_f32 v254, v254, v213
    v_add_f32 v254, v254, v214
    v_add_f32 v254, v254, v215
    v_cvt_pk_bf16_f32 v224, v208, v209
    v_cvt_pk_bf16_f32 v225, v210, v211
    v_cvt_pk_bf16_f32 v226, v212, v213
    v_cvt_pk_bf16_f32 v227, v214, v215
    s_nop 1
    s_branch Lcont_52
Lrare_53:
    v_mov_b32 v253, v247
    ds_read_b128 v[228:231], v253 offset:0
    s_waitcnt lgkmcnt(0)
    v_mfma_f32_16x16x32_bf16 v[216:219], v[228:231], v[112:115], v[236:239]
    s_nop 3
    ds_read_b128 v[228:231], v253 offset:64
    s_waitcnt lgkmcnt(0)
    v_mfma_f32_16x16x32_bf16 v[216:219], v[228:231], v[116:119], v[216:219]
    s_nop 3
    ds_read_b128 v[228:231], v253 offset:128
    s_waitcnt lgkmcnt(0)
    v_mfma_f32_16x16x32_bf16 v[216:219], v[228:231], v[120:123], v[216:219]
    s_nop 3
    ds_read_b128 v[228:231], v253 offset:192
    s_waitcnt lgkmcnt(0)
    v_mfma_f32_16x16x32_bf16 v[216:219], v[228:231], v[124:127], v[216:219]
    s_nop 3
    ds_read_b128 v[228:231], v253 offset:4352
    s_waitcnt lgkmcnt(0)
    v_mfma_f32_16x16x32_bf16 v[220:223], v[228:231], v[112:115], v[236:239]
    s_nop 3
    ds_read_b128 v[228:231], v253 offset:4416
    s_waitcnt lgkmcnt(0)
    v_mfma_f32_16x16x32_bf16 v[220:223], v[228:231], v[116:119], v[220:223]
    s_nop 3
    ds_read_b128 v[228:231], v253 offset:4480
    s_waitcnt lgkmcnt(0)
    v_mfma_f32_16x16x32_bf16 v[220:223], v[228:231], v[120:123], v[220:223]
    s_nop 3
    ds_read_b128 v[228:231], v253 offset:4544
    s_waitcnt lgkmcnt(0)
    v_mfma_f32_16x16x32_bf16 v[220:223], v[228:231], v[124:127], v[220:223]
    s_nop 3
    s_nop 7
    v_max3_f32 v252, v216, v217, v218
    v_max3_f32 v253, v219, v220, v221
    v_max3_f32 v252, v252, v222, v223
    v_max_f32 v252, v252, v253
    v_mov_b32 v253, v252
    s_nop 1
    v_permlane32_swap_b32 v252, v253
    v_max_f32 v252, v252, v253
    v_mov_b32 v253, v252
    s_nop 1
    v_permlane16_swap_b32 v252, v253
    v_max_f32 v252, v252, v253
    v_max_f32 v252, 0, v252
    v_sub_f32 v253, 0, v252
    v_exp_f32 v253, v253
    s_nop 0
    v_mul_f32 v245, v245, v253
    v_mul_f32 v32, v32, v253
    v_mul_f32 v33, v33, v253
    v_mul_f32 v34, v34, v253
    v_mul_f32 v35, v35, v253
    v_mul_f32 v36, v36, v253
    v_mul_f32 v37, v37, v253
    v_mul_f32 v38, v38, v253
    v_mul_f32 v39, v39, v253
    v_mul_f32 v40, v40, v253
    v_mul_f32 v41, v41, v253
    v_mul_f32 v42, v42, v253
    v_mul_f32 v43, v43, v253
    v_mul_f32 v44, v44, v253
    v_mul_f32 v45, v45, v253
    v_mul_f32 v46, v46, v253
    v_mul_f32 v47, v47, v253
    v_mul_f32 v48, v48, v253
    v_mul_f32 v49, v49, v253
    v_mul_f32 v50, v50, v253
    v_mul_f32 v51, v51, v253
    v_mul_f32 v52, v52, v253
    v_mul_f32 v53, v53, v253
    v_mul_f32 v54, v54, v253
    v_mul_f32 v55, v55, v253
    v_mul_f32 v56, v56, v253
    v_mul_f32 v57, v57, v253
    v_mul_f32 v58, v58, v253
    v_mul_f32 v59, v59, v253
    v_mul_f32 v60, v60, v253
    v_mul_f32 v61, v61, v253
    v_mul_f32 v62, v62, v253
    v_mul_f32 v63, v63, v253
    v_sub_f32 v236, v236, v252
    v_sub_f32 v237, v237, v252
    v_sub_f32 v238, v238, v252
    v_sub_f32 v239, v239, v252
    v_sub_f32 v216, v216, v252
    v_sub_f32 v217, v217, v252
    v_sub_f32 v218, v218, v252
    v_sub_f32 v219, v219, v252
    v_sub_f32 v220, v220, v252
    v_sub_f32 v221, v221, v252
    v_sub_f32 v222, v222, v252
    v_sub_f32 v223, v223, v252
    v_exp_f32 v216, v216
    v_exp_f32 v217, v217
    v_exp_f32 v218, v218
    v_exp_f32 v219, v219
    v_exp_f32 v220, v220
    v_exp_f32 v221, v221
    v_exp_f32 v222, v222
    v_exp_f32 v223, v223
    s_nop 0
    v_add_f32 v254, v216, v217
    v_add_f32 v254, v254, v218
    v_add_f32 v254, v254, v219
    v_add_f32 v254, v254, v220
    v_add_f32 v254, v254, v221
    v_add_f32 v254, v254, v222
    v_add_f32 v254, v254, v223
    v_cvt_pk_bf16_f32 v228, v216, v217
    v_cvt_pk_bf16_f32 v229, v218, v219
    v_cvt_pk_bf16_f32 v230, v220, v221
    v_cvt_pk_bf16_f32 v231, v222, v223
    s_nop 1
    s_branch Lcont_54
Lrare_55:
    v_mov_b32 v253, v247
    ds_read_b128 v[224:227], v253 offset:0
    s_waitcnt lgkmcnt(0)
    v_mfma_f32_16x16x32_bf16 v[208:211], v[224:227], v[128:131], v[240:243]
    s_nop 3
    ds_read_b128 v[224:227], v253 offset:64
    s_waitcnt lgkmcnt(0)
    v_mfma_f32_16x16x32_bf16 v[208:211], v[224:227], v[132:135], v[208:211]
    s_nop 3
    ds_read_b128 v[224:227], v253 offset:128
    s_waitcnt lgkmcnt(0)
    v_mfma_f32_16x16x32_bf16 v[208:211], v[224:227], v[136:139], v[208:211]
    s_nop 3
    ds_read_b128 v[224:227], v253 offset:192
    s_waitcnt lgkmcnt(0)
    v_mfma_f32_16x16x32_bf16 v[208:211], v[224:227], v[140:143], v[208:211]
    s_nop 3
    ds_read_b128 v[224:227], v253 offset:4352
    s_waitcnt lgkmcnt(0)
    v_mfma_f32_16x16x32_bf16 v[212:215], v[224:227], v[128:131], v[240:243]
    s_nop 3
    ds_read_b128 v[224:227], v253 offset:4416
    s_waitcnt lgkmcnt(0)
    v_mfma_f32_16x16x32_bf16 v[212:215], v[224:227], v[132:135], v[212:215]
    s_nop 3
    ds_read_b128 v[224:227], v253 offset:4480
    s_waitcnt lgkmcnt(0)
    v_mfma_f32_16x16x32_bf16 v[212:215], v[224:227], v[136:139], v[212:215]
    s_nop 3
    ds_read_b128 v[224:227], v253 offset:4544
    s_waitcnt lgkmcnt(0)
    v_mfma_f32_16x16x32_bf16 v[212:215], v[224:227], v[140:143], v[212:215]
    s_nop 3
    s_nop 7
    v_max3_f32 v252, v208, v209, v210
    v_max3_f32 v253, v211, v212, v213
    v_max3_f32 v252, v252, v214, v215
    v_max_f32 v252, v252, v253
    v_mov_b32 v253, v252
    s_nop 1
    v_permlane32_swap_b32 v252, v253
    v_max_f32 v252, v252, v253
    v_mov_b32 v253, v252
    s_nop 1
    v_permlane16_swap_b32 v252, v253
    v_max_f32 v252, v252, v253
    v_max_f32 v252, 0, v252
    v_sub_f32 v253, 0, v252
    v_exp_f32 v253, v253
    s_nop 0
    v_mul_f32 v246, v246, v253
    v_mul_f32 v64, v64, v253
    v_mul_f32 v65, v65, v253
    v_mul_f32 v66, v66, v253
    v_mul_f32 v67, v67, v253
    v_mul_f32 v68, v68, v253
    v_mul_f32 v69, v69, v253
    v_mul_f32 v70, v70, v253
    v_mul_f32 v71, v71, v253
    v_mul_f32 v72, v72, v253
    v_mul_f32 v73, v73, v253
    v_mul_f32 v74, v74, v253
    v_mul_f32 v75, v75, v253
    v_mul_f32 v76, v76, v253
    v_mul_f32 v77, v77, v253
    v_mul_f32 v78, v78, v253
    v_mul_f32 v79, v79, v253
    v_mul_f32 v80, v80, v253
    v_mul_f32 v81, v81, v253
    v_mul_f32 v82, v82, v253
    v_mul_f32 v83, v83, v253
    v_mul_f32 v84, v84, v253
    v_mul_f32 v85, v85, v253
    v_mul_f32 v86, v86, v253
    v_mul_f32 v87, v87, v253
    v_mul_f32 v88, v88, v253
    v_mul_f32 v89, v89, v253
    v_mul_f32 v90, v90, v253
    v_mul_f32 v91, v91, v253
    v_mul_f32 v92, v92, v253
    v_mul_f32 v93, v93, v253
    v_mul_f32 v94, v94, v253
    v_mul_f32 v95, v95, v253
    v_sub_f32 v240, v240, v252
    v_sub_f32 v241, v241, v252
    v_sub_f32 v242, v242, v252
    v_sub_f32 v243, v243, v252
    v_sub_f32 v208, v208, v252
    v_sub_f32 v209, v209, v252
    v_sub_f32 v210, v210, v252
    v_sub_f32 v211, v211, v252
    v_sub_f32 v212, v212, v252
    v_sub_f32 v213, v213, v252
    v_sub_f32 v214, v214, v252
    v_sub_f32 v215, v215, v252
    v_exp_f32 v208, v208
    v_exp_f32 v209, v209
    v_exp_f32 v210, v210
    v_exp_f32 v211, v211
    v_exp_f32 v212, v212
    v_exp_f32 v213, v213
    v_exp_f32 v214, v214
    v_exp_f32 v215, v215
    s_nop 0
    v_add_f32 v254, v208, v209
    v_add_f32 v254, v254, v210
    v_add_f32 v254, v254, v211
    v_add_f32 v254, v254, v212
    v_add_f32 v254, v254, v213
    v_add_f32 v254, v254, v214
    v_add_f32 v254, v254, v215
    v_cvt_pk_bf16_f32 v224, v208, v209
    v_cvt_pk_bf16_f32 v225, v210, v211
    v_cvt_pk_bf16_f32 v226, v212, v213
    v_cvt_pk_bf16_f32 v227, v214, v215
    s_nop 1
    s_branch Lcont_56
Lrare_57:
    v_mov_b32 v253, v247
    ds_read_b128 v[228:231], v253 offset:8704
    s_waitcnt lgkmcnt(0)
    v_mfma_f32_16x16x32_bf16 v[216:219], v[228:231], v[96:99], v[232:235]
    s_nop 3
    ds_read_b128 v[228:231], v253 offset:8768
    s_waitcnt lgkmcnt(0)
    v_mfma_f32_16x16x32_bf16 v[216:219], v[228:231], v[100:103], v[216:219]
    s_nop 3
    ds_read_b128 v[228:231], v253 offset:8832
    s_waitcnt lgkmcnt(0)
    v_mfma_f32_16x16x32_bf16 v[216:219], v[228:231], v[104:107], v[216:219]
    s_nop 3
    ds_read_b128 v[228:231], v253 offset:8896
    s_waitcnt lgkmcnt(0)
    v_mfma_f32_16x16x32_bf16 v[216:219], v[228:231], v[108:111], v[216:219]
    s_nop 3
    ds_read_b128 v[228:231], v253 offset:13056
    s_waitcnt lgkmcnt(0)
    v_mfma_f32_16x16x32_bf16 v[220:223], v[228:231], v[96:99], v[232:235]
    s_nop 3
    ds_read_b128 v[228:231], v253 offset:13120
    s_waitcnt lgkmcnt(0)
    v_mfma_f32_16x16x32_bf16 v[220:223], v[228:231], v[100:103], v[220:223]
    s_nop 3
    ds_read_b128 v[228:231], v253 offset:13184
    s_waitcnt lgkmcnt(0)
    v_mfma_f32_16x16x32_bf16 v[220:223], v[228:231], v[104:107], v[220:223]
    s_nop 3
    ds_read_b128 v[228:231], v253 offset:13248
    s_waitcnt lgkmcnt(0)
    v_mfma_f32_16x16x32_bf16 v[220:223], v[228:231], v[108:111], v[220:223]
    s_nop 3
    s_nop 7
    v_max3_f32 v252, v216, v217, v218
    v_max3_f32 v253, v219, v220, v221
    v_max3_f32 v252, v252, v222, v223
    v_max_f32 v252, v252, v253
    v_mov_b32 v253, v252
    s_nop 1
    v_permlane32_swap_b32 v252, v253
    v_max_f32 v252, v252, v253
    v_mov_b32 v253, v252
    s_nop 1
    v_permlane16_swap_b32 v252, v253
    v_max_f32 v252, v252, v253
    v_max_f32 v252, 0, v252
    v_sub_f32 v253, 0, v252
    v_exp_f32 v253, v253
    s_nop 0
    v_mul_f32 v244, v244, v253
    v_mul_f32 v0, v0, v253
    v_mul_f32 v1, v1, v253
    v_mul_f32 v2, v2, v253
    v_mul_f32 v3, v3, v253
    v_mul_f32 v4, v4, v253
    v_mul_f32 v5, v5, v253
    v_mul_f32 v6, v6, v253
    v_mul_f32 v7, v7, v253
    v_mul_f32 v8, v8, v253
    v_mul_f32 v9, v9, v253
    v_mul_f32 v10, v10, v253
    v_mul_f32 v11, v11, v253
    v_mul_f32 v12, v12, v253
    v_mul_f32 v13, v13, v253
    v_mul_f32 v14, v14, v253
    v_mul_f32 v15, v15, v253
    v_mul_f32 v16, v16, v253
    v_mul_f32 v17, v17, v253
    v_mul_f32 v18, v18, v253
    v_mul_f32 v19, v19, v253
    v_mul_f32 v20, v20, v253
    v_mul_f32 v21, v21, v253
    v_mul_f32 v22, v22, v253
    v_mul_f32 v23, v23, v253
    v_mul_f32 v24, v24, v253
    v_mul_f32 v25, v25, v253
    v_mul_f32 v26, v26, v253
    v_mul_f32 v27, v27, v253
    v_mul_f32 v28, v28, v253
    v_mul_f32 v29, v29, v253
    v_mul_f32 v30, v30, v253
    v_mul_f32 v31, v31, v253
    v_sub_f32 v232, v232, v252
    v_sub_f32 v233, v233, v252
    v_sub_f32 v234, v234, v252
    v_sub_f32 v235, v235, v252
    v_sub_f32 v216, v216, v252
    v_sub_f32 v217, v217, v252
    v_sub_f32 v218, v218, v252
    v_sub_f32 v219, v219, v252
    v_sub_f32 v220, v220, v252
    v_sub_f32 v221, v221, v252
    v_sub_f32 v222, v222, v252
    v_sub_f32 v223, v223, v252
    v_exp_f32 v216, v216
    v_exp_f32 v217, v217
    v_exp_f32 v218, v218
    v_exp_f32 v219, v219
    v_exp_f32 v220, v220
    v_exp_f32 v221, v221
    v_exp_f32 v222, v222
    v_exp_f32 v223, v223
    s_nop 0
    v_add_f32 v254, v216, v217
    v_add_f32 v254, v254, v218
    v_add_f32 v254, v254, v219
    v_add_f32 v254, v254, v220
    v_add_f32 v254, v254, v221
    v_add_f32 v254, v254, v222
    v_add_f32 v254, v254, v223
    v_cvt_pk_bf16_f32 v228, v216, v217
    v_cvt_pk_bf16_f32 v229, v218, v219
    v_cvt_pk_bf16_f32 v230, v220, v221
    v_cvt_pk_bf16_f32 v231, v222, v223
    s_nop 1
    s_branch Lcont_58
Lrare_59:
    v_subrev_u32 v253, s56, v247
    ds_read_b128 v[224:227], v253 offset:8704
    s_waitcnt lgkmcnt(0)
    v_mfma_f32_16x16x32_bf16 v[208:211], v[224:227], v[112:115], v[236:239]
    s_nop 3
    ds_read_b128 v[224:227], v253 offset:8768
    s_waitcnt lgkmcnt(0)
    v_mfma_f32_16x16x32_bf16 v[208:211], v[224:227], v[116:119], v[208:211]
    s_nop 3
    ds_read_b128 v[224:227], v253 offset:8832
    s_waitcnt lgkmcnt(0)
    v_mfma_f32_16x16x32_bf16 v[208:211], v[224:227], v[120:123], v[208:211]
    s_nop 3
    ds_read_b128 v[224:227], v253 offset:8896
    s_waitcnt lgkmcnt(0)
    v_mfma_f32_16x16x32_bf16 v[208:211], v[224:227], v[124:127], v[208:211]
    s_nop 3
    ds_read_b128 v[224:227], v253 offset:13056
    s_waitcnt lgkmcnt(0)
    v_mfma_f32_16x16x32_bf16 v[212:215], v[224:227], v[112:115], v[236:239]
    s_nop 3
    ds_read_b128 v[224:227], v253 offset:13120
    s_waitcnt lgkmcnt(0)
    v_mfma_f32_16x16x32_bf16 v[212:215], v[224:227], v[116:119], v[212:215]
    s_nop 3
    ds_read_b128 v[224:227], v253 offset:13184
    s_waitcnt lgkmcnt(0)
    v_mfma_f32_16x16x32_bf16 v[212:215], v[224:227], v[120:123], v[212:215]
    s_nop 3
    ds_read_b128 v[224:227], v253 offset:13248
    s_waitcnt lgkmcnt(0)
    v_mfma_f32_16x16x32_bf16 v[212:215], v[224:227], v[124:127], v[212:215]
    s_nop 3
    s_nop 7
    v_max3_f32 v252, v208, v209, v210
    v_max3_f32 v253, v211, v212, v213
    v_max3_f32 v252, v252, v214, v215
    v_max_f32 v252, v252, v253
    v_mov_b32 v253, v252
    s_nop 1
    v_permlane32_swap_b32 v252, v253
    v_max_f32 v252, v252, v253
    v_mov_b32 v253, v252
    s_nop 1
    v_permlane16_swap_b32 v252, v253
    v_max_f32 v252, v252, v253
    v_max_f32 v252, 0, v252
    v_sub_f32 v253, 0, v252
    v_exp_f32 v253, v253
    s_nop 0
    v_mul_f32 v245, v245, v253
    v_mul_f32 v32, v32, v253
    v_mul_f32 v33, v33, v253
    v_mul_f32 v34, v34, v253
    v_mul_f32 v35, v35, v253
    v_mul_f32 v36, v36, v253
    v_mul_f32 v37, v37, v253
    v_mul_f32 v38, v38, v253
    v_mul_f32 v39, v39, v253
    v_mul_f32 v40, v40, v253
    v_mul_f32 v41, v41, v253
    v_mul_f32 v42, v42, v253
    v_mul_f32 v43, v43, v253
    v_mul_f32 v44, v44, v253
    v_mul_f32 v45, v45, v253
    v_mul_f32 v46, v46, v253
    v_mul_f32 v47, v47, v253
    v_mul_f32 v48, v48, v253
    v_mul_f32 v49, v49, v253
    v_mul_f32 v50, v50, v253
    v_mul_f32 v51, v51, v253
    v_mul_f32 v52, v52, v253
    v_mul_f32 v53, v53, v253
    v_mul_f32 v54, v54, v253
    v_mul_f32 v55, v55, v253
    v_mul_f32 v56, v56, v253
    v_mul_f32 v57, v57, v253
    v_mul_f32 v58, v58, v253
    v_mul_f32 v59, v59, v253
    v_mul_f32 v60, v60, v253
    v_mul_f32 v61, v61, v253
    v_mul_f32 v62, v62, v253
    v_mul_f32 v63, v63, v253
    v_sub_f32 v236, v236, v252
    v_sub_f32 v237, v237, v252
    v_sub_f32 v238, v238, v252
    v_sub_f32 v239, v239, v252
    v_sub_f32 v208, v208, v252
    v_sub_f32 v209, v209, v252
    v_sub_f32 v210, v210, v252
    v_sub_f32 v211, v211, v252
    v_sub_f32 v212, v212, v252
    v_sub_f32 v213, v213, v252
    v_sub_f32 v214, v214, v252
    v_sub_f32 v215, v215, v252
    v_exp_f32 v208, v208
    v_exp_f32 v209, v209
    v_exp_f32 v210, v210
    v_exp_f32 v211, v211
    v_exp_f32 v212, v212
    v_exp_f32 v213, v213
    v_exp_f32 v214, v214
    v_exp_f32 v215, v215
    s_nop 0
    v_add_f32 v254, v208, v209
    v_add_f32 v254, v254, v210
    v_add_f32 v254, v254, v211
    v_add_f32 v254, v254, v212
    v_add_f32 v254, v254, v213
    v_add_f32 v254, v254, v214
    v_add_f32 v254, v254, v215
    v_cvt_pk_bf16_f32 v224, v208, v209
    v_cvt_pk_bf16_f32 v225, v210, v211
    v_cvt_pk_bf16_f32 v226, v212, v213
    v_cvt_pk_bf16_f32 v227, v214, v215
    s_nop 1
    s_branch Lcont_60
Lrare_62:
    v_subrev_u32 v253, s56, v247
    ds_read_b128 v[228:231], v253 offset:8704
    s_waitcnt lgkmcnt(0)
    v_mfma_f32_16x16x32_bf16 v[216:219], v[228:231], v[128:131], v[240:243]
    s_nop 3
    ds_read_b128 v[228:231], v253 offset:8768
    s_waitcnt lgkmcnt(0)
    v_mfma_f32_16x16x32_bf16 v[216:219], v[228:231], v[132:135], v[216:219]
    s_nop 3
    ds_read_b128 v[228:231], v253 offset:8832
    s_waitcnt lgkmcnt(0)
    v_mfma_f32_16x16x32_bf16 v[216:219], v[228:231], v[136:139], v[216:219]
    s_nop 3
    ds_read_b128 v[228:231], v253 offset:8896
    s_waitcnt lgkmcnt(0)
    v_mfma_f32_16x16x32_bf16 v[216:219], v[228:231], v[140:143], v[216:219]
    s_nop 3
    ds_read_b128 v[228:231], v253 offset:13056
    s_waitcnt lgkmcnt(0)
    v_mfma_f32_16x16x32_bf16 v[220:223], v[228:231], v[128:131], v[240:243]
    s_nop 3
    ds_read_b128 v[228:231], v253 offset:13120
    s_waitcnt lgkmcnt(0)
    v_mfma_f32_16x16x32_bf16 v[220:223], v[228:231], v[132:135], v[220:223]
    s_nop 3
    ds_read_b128 v[228:231], v253 offset:13184
    s_waitcnt lgkmcnt(0)
    v_mfma_f32_16x16x32_bf16 v[220:223], v[228:231], v[136:139], v[220:223]
    s_nop 3
    ds_read_b128 v[228:231], v253 offset:13248
    s_waitcnt lgkmcnt(0)
    v_mfma_f32_16x16x32_bf16 v[220:223], v[228:231], v[140:143], v[220:223]
    s_nop 3
    s_nop 7
    v_max3_f32 v252, v216, v217, v218
    v_max3_f32 v253, v219, v220, v221
    v_max3_f32 v252, v252, v222, v223
    v_max_f32 v252, v252, v253
    v_mov_b32 v253, v252
    s_nop 1
    v_permlane32_swap_b32 v252, v253
    v_max_f32 v252, v252, v253
    v_mov_b32 v253, v252
    s_nop 1
    v_permlane16_swap_b32 v252, v253
    v_max_f32 v252, v252, v253
    v_max_f32 v252, 0, v252
    v_sub_f32 v253, 0, v252
    v_exp_f32 v253, v253
    s_nop 0
    v_mul_f32 v246, v246, v253
    v_mul_f32 v64, v64, v253
    v_mul_f32 v65, v65, v253
    v_mul_f32 v66, v66, v253
    v_mul_f32 v67, v67, v253
    v_mul_f32 v68, v68, v253
    v_mul_f32 v69, v69, v253
    v_mul_f32 v70, v70, v253
    v_mul_f32 v71, v71, v253
    v_mul_f32 v72, v72, v253
    v_mul_f32 v73, v73, v253
    v_mul_f32 v74, v74, v253
    v_mul_f32 v75, v75, v253
    v_mul_f32 v76, v76, v253
    v_mul_f32 v77, v77, v253
    v_mul_f32 v78, v78, v253
    v_mul_f32 v79, v79, v253
    v_mul_f32 v80, v80, v253
    v_mul_f32 v81, v81, v253
    v_mul_f32 v82, v82, v253
    v_mul_f32 v83, v83, v253
    v_mul_f32 v84, v84, v253
    v_mul_f32 v85, v85, v253
    v_mul_f32 v86, v86, v253
    v_mul_f32 v87, v87, v253
    v_mul_f32 v88, v88, v253
    v_mul_f32 v89, v89, v253
    v_mul_f32 v90, v90, v253
    v_mul_f32 v91, v91, v253
    v_mul_f32 v92, v92, v253
    v_mul_f32 v93, v93, v253
    v_mul_f32 v94, v94, v253
    v_mul_f32 v95, v95, v253
    v_sub_f32 v240, v240, v252
    v_sub_f32 v241, v241, v252
    v_sub_f32 v242, v242, v252
    v_sub_f32 v243, v243, v252
    v_sub_f32 v216, v216, v252
    v_sub_f32 v217, v217, v252
    v_sub_f32 v218, v218, v252
    v_sub_f32 v219, v219, v252
    v_sub_f32 v220, v220, v252
    v_sub_f32 v221, v221, v252
    v_sub_f32 v222, v222, v252
    v_sub_f32 v223, v223, v252
    v_exp_f32 v216, v216
    v_exp_f32 v217, v217
    v_exp_f32 v218, v218
    v_exp_f32 v219, v219
    v_exp_f32 v220, v220
    v_exp_f32 v221, v221
    v_exp_f32 v222, v222
    v_exp_f32 v223, v223
    s_nop 0
    v_add_f32 v254, v216, v217
    v_add_f32 v254, v254, v218
    v_add_f32 v254, v254, v219
    v_add_f32 v254, v254, v220
    v_add_f32 v254, v254, v221
    v_add_f32 v254, v254, v222
    v_add_f32 v254, v254, v223
    v_cvt_pk_bf16_f32 v228, v216, v217
    v_cvt_pk_bf16_f32 v229, v218, v219
    v_cvt_pk_bf16_f32 v230, v220, v221
    v_cvt_pk_bf16_f32 v231, v222, v223
    s_nop 1
    s_branch Lcont_63
L_kvloader:
    s_waitcnt lgkmcnt(0)
    s_lshl_b32 s48, s45, 4
    s_add_u32 s48, s48, s46
    s_lshl_b32 s49, s48, 18
    s_add_u32 s20, s6, s49
    s_addc_u32 s21, s7, 0
    s_mov_b32 s22, 262144
    s_mov_b32 s23, 0x20000
    s_add_u32 s24, s8, s49
    s_addc_u32 s25, s9, 0
    s_mov_b32 s26, 262144
    s_mov_b32 s27, 0x20000
    s_mul_i32 s49, s48, 110592
    s_add_u32 s49, s49, 1048576
    s_add_u32 s40, s18, s49
    s_addc_u32 s41, s19, 0
    s_mov_b32 s42, 110592
    s_mov_b32 s43, 0x20000
    s_mul_i32 s49, s45, 110592
    s_add_u32 s12, s14, s49
    s_addc_u32 s13, s15, 0
    s_mov_b32 s14, 110592
    s_mov_b32 s15, 0x20000
    s_mul_i32 s49, s45, 1769472
    s_add_u32 s49, s49, 1048576
    s_add_u32 s4, s18, s49
    s_addc_u32 s5, s19, 0
    s_mov_b32 s6, 1769472
    s_mov_b32 s7, 0x20000
    s_mul_i32 s49, s45, 1152
    s_add_u32 s49, s49, 524288
    s_add_u32 s8, s18, s49
    s_addc_u32 s9, s19, 0
    s_mov_b32 s10, 1152
    s_mov_b32 s11, 0x20000
    s_sub_u32 s47, s47, 2
    v_lshrrev_b32 v2, 4, v1
    v_and_b32 v3, 15, v1
    s_lshl_b32 s48, s47, 13
    v_lshlrev_b32 v4, 8, v2
    v_add_u32 v4, s48, v4
    v_xor_b32 v5, v2, v3
    v_lshlrev_b32 v5, 4, v5
    v_add_u32 v10, v4, v5
    v_lshlrev_b32 v5, 1, v2
    v_xor_b32 v5, v5, v3
    v_lshlrev_b32 v5, 4, v5
    v_add_u32 v11, v4, v5
    s_mul_i32 s52, s47, 8704
    s_mul_i32 s59, s47, 9216
    s_cmp_lg_u32 s47, 1
    s_cbranch_scc1 Lcp0_65
    s_getpc_b64 s[94:95]
Lcpf_66:
    s_sub_u32 s94, s94, (Lcpf_66 - standalone__gqa_block_cached__near_ridge_kernel)
    s_subb_u32 s95, s95, 0
    s_lshl_b32 s48, s68, 11
    v_and_b32 v34, 15, v1
    v_lshlrev_b32 v34, 7, v34
    v_add_u32 v34, s48, v34
    v_min_u32 v34, (L_k1_end - standalone__gqa_block_cached__near_ridge_kernel), v34
    global_load_dword v35, v34, s[94:95]
Lcp0_65:
    s_cmp_lg_u32 s47, 1
    s_cbranch_scc1 Lclr_67
    v_mov_b32 v20, 0
    v_mov_b32 v21, 0
    s_lshl_b32 s48, s46, 3
    v_lshlrev_b32 v5, 7, v1
    v_add_u32 v5, s48, v5
    v_mov_b32 v7, 0x40000000
    v_cmp_gt_u32 vcc, 9, v1
    s_nop 1
    v_cndmask_b32 v5, v7, v5, vcc
    buffer_store_dwordx2 v[20:21], v5, s[8:11], 0 offen sc0 sc1
Lclr_67:
    s_barrier
    s_barrier
    s_barrier
    s_barrier
    s_barrier
    s_cmp_lg_u32 s47, 1
    s_cbranch_scc1 Lclr_68
    s_waitcnt vmcnt(0)
    s_lshl_b32 s48, s45, 4
    v_mov_b32 v5, s48
    v_mov_b32 v6, 1
    s_mov_b64 s[96:97], exec
    s_mov_b64 exec, 1
    global_atomic_add v5, v6, s[16:17] sc1
    s_mov_b64 exec, s[96:97]
Lclr_68:
    s_barrier
    s_barrier
    s_barrier
    s_barrier
    s_barrier
    s_barrier
    s_barrier
    s_barrier
    s_mov_b32 s48, 0
    s_add_u32 m0, s52, 0
    s_nop 0
    buffer_load_dwordx4 v10, s[20:23], s48 offen offset:0 nt lds
    s_add_u32 m0, s52, 64
    s_nop 0
    buffer_load_dwordx4 v10, s[20:23], s48 offen offset:1024 nt lds
    s_add_u32 m0, s52, 128
    s_nop 0
    buffer_load_dwordx4 v10, s[20:23], s48 offen offset:2048 nt lds
    s_add_u32 m0, s52, 192
    s_nop 0
    buffer_load_dwordx4 v10, s[20:23], s48 offen offset:3072 nt lds
    s_barrier
    s_mov_b32 s48, 4096
    s_add_u32 m0, s52, 4352
    s_nop 0
    buffer_load_dwordx4 v10, s[20:23], s48 offen offset:0 nt lds
    s_add_u32 m0, s52, 4416
    s_nop 0
    buffer_load_dwordx4 v10, s[20:23], s48 offen offset:1024 nt lds
    s_add_u32 m0, s52, 4480
    s_nop 0
    buffer_load_dwordx4 v10, s[20:23], s48 offen offset:2048 nt lds
    s_add_u32 m0, s52, 4544
    s_nop 0
    buffer_load_dwordx4 v10, s[20:23], s48 offen offset:3072 nt lds
    s_barrier
    s_mov_b32 s48, 0
    s_add_u32 m0, s59, 17408
    s_nop 0
    buffer_load_dwordx4 v11, s[24:27], s48 offen offset:0 nt lds
    s_add_u32 m0, s59, 17536
    s_nop 0
    buffer_load_dwordx4 v11, s[24:27], s48 offen offset:1024 nt lds
    s_add_u32 m0, s59, 17664
    s_nop 0
    buffer_load_dwordx4 v11, s[24:27], s48 offen offset:2048 nt lds
    s_add_u32 m0, s59, 17792
    s_nop 0
    buffer_load_dwordx4 v11, s[24:27], s48 offen offset:3072 nt lds
    s_barrier
    s_mov_b32 s48, 4096
    s_add_u32 m0, s59, 22016
    s_nop 0
    buffer_load_dwordx4 v11, s[24:27], s48 offen offset:0 nt lds
    s_add_u32 m0, s59, 22144
    s_nop 0
    buffer_load_dwordx4 v11, s[24:27], s48 offen offset:1024 nt lds
    s_add_u32 m0, s59, 22272
    s_nop 0
    buffer_load_dwordx4 v11, s[24:27], s48 offen offset:2048 nt lds
    s_add_u32 m0, s59, 22400
    s_nop 0
    buffer_load_dwordx4 v11, s[24:27], s48 offen offset:3072 nt lds
    s_barrier
    s_barrier
    s_barrier
    s_mov_b32 s48, 16384
    s_add_u32 m0, s52, 35840
    s_nop 0
    buffer_load_dwordx4 v10, s[20:23], s48 offen offset:0 nt lds
    s_add_u32 m0, s52, 35904
    s_nop 0
    buffer_load_dwordx4 v10, s[20:23], s48 offen offset:1024 nt lds
    s_add_u32 m0, s52, 35968
    s_nop 0
    buffer_load_dwordx4 v10, s[20:23], s48 offen offset:2048 nt lds
    s_add_u32 m0, s52, 36032
    s_nop 0
    buffer_load_dwordx4 v10, s[20:23], s48 offen offset:3072 nt lds
    s_mov_b32 s48, 20480
    s_add_u32 m0, s52, 40192
    s_nop 0
    buffer_load_dwordx4 v10, s[20:23], s48 offen offset:0 nt lds
    s_add_u32 m0, s52, 40256
    s_nop 0
    buffer_load_dwordx4 v10, s[20:23], s48 offen offset:1024 nt lds
    s_add_u32 m0, s52, 40320
    s_nop 0
    buffer_load_dwordx4 v10, s[20:23], s48 offen offset:2048 nt lds
    s_add_u32 m0, s52, 40384
    s_nop 0
    buffer_load_dwordx4 v10, s[20:23], s48 offen offset:3072 nt lds
    s_mov_b32 s48, 16384
    s_add_u32 m0, s59, 53248
    s_nop 0
    buffer_load_dwordx4 v11, s[24:27], s48 offen offset:0 nt lds
    s_add_u32 m0, s59, 53376
    s_nop 0
    buffer_load_dwordx4 v11, s[24:27], s48 offen offset:1024 nt lds
    s_add_u32 m0, s59, 53504
    s_nop 0
    buffer_load_dwordx4 v11, s[24:27], s48 offen offset:2048 nt lds
    s_add_u32 m0, s59, 53632
    s_nop 0
    buffer_load_dwordx4 v11, s[24:27], s48 offen offset:3072 nt lds
    s_mov_b32 s48, 20480
    s_add_u32 m0, s59, 57856
    s_nop 0
    buffer_load_dwordx4 v11, s[24:27], s48 offen offset:0 nt lds
    s_add_u32 m0, s59, 57984
    s_nop 0
    buffer_load_dwordx4 v11, s[24:27], s48 offen offset:1024 nt lds
    s_add_u32 m0, s59, 58112
    s_nop 0
    buffer_load_dwordx4 v11, s[24:27], s48 offen offset:2048 nt lds
    s_add_u32 m0, s59, 58240
    s_nop 0
    buffer_load_dwordx4 v11, s[24:27], s48 offen offset:3072 nt lds
    s_waitcnt vmcnt(16)
    s_barrier
    s_mov_b32 s48, 32768
    s_add_u32 m0, s52, 71680
    s_nop 0
    buffer_load_dwordx4 v10, s[20:23], s48 offen offset:0 nt lds
    s_add_u32 m0, s52, 71744
    s_nop 0
    buffer_load_dwordx4 v10, s[20:23], s48 offen offset:1024 nt lds
    s_add_u32 m0, s52, 71808
    s_nop 0
    buffer_load_dwordx4 v10, s[20:23], s48 offen offset:2048 nt lds
    s_add_u32 m0, s52, 71872
    s_nop 0
    buffer_load_dwordx4 v10, s[20:23], s48 offen offset:3072 nt lds
    s_mov_b32 s48, 36864
    s_add_u32 m0, s52, 76032
    s_nop 0
    buffer_load_dwordx4 v10, s[20:23], s48 offen offset:0 nt lds
    s_add_u32 m0, s52, 76096
    s_nop 0
    buffer_load_dwordx4 v10, s[20:23], s48 offen offset:1024 nt lds
    s_add_u32 m0, s52, 76160
    s_nop 0
    buffer_load_dwordx4 v10, s[20:23], s48 offen offset:2048 nt lds
    s_add_u32 m0, s52, 76224
    s_nop 0
    buffer_load_dwordx4 v10, s[20:23], s48 offen offset:3072 nt lds
    s_mov_b32 s48, 32768
    s_add_u32 m0, s59, 89088
    s_nop 0
    buffer_load_dwordx4 v11, s[24:27], s48 offen offset:0 nt lds
    s_add_u32 m0, s59, 89216
    s_nop 0
    buffer_load_dwordx4 v11, s[24:27], s48 offen offset:1024 nt lds
    s_add_u32 m0, s59, 89344
    s_nop 0
    buffer_load_dwordx4 v11, s[24:27], s48 offen offset:2048 nt lds
    s_add_u32 m0, s59, 89472
    s_nop 0
    buffer_load_dwordx4 v11, s[24:27], s48 offen offset:3072 nt lds
    s_mov_b32 s48, 36864
    s_add_u32 m0, s59, 93696
    s_nop 0
    buffer_load_dwordx4 v11, s[24:27], s48 offen offset:0 nt lds
    s_add_u32 m0, s59, 93824
    s_nop 0
    buffer_load_dwordx4 v11, s[24:27], s48 offen offset:1024 nt lds
    s_add_u32 m0, s59, 93952
    s_nop 0
    buffer_load_dwordx4 v11, s[24:27], s48 offen offset:2048 nt lds
    s_add_u32 m0, s59, 94080
    s_nop 0
    buffer_load_dwordx4 v11, s[24:27], s48 offen offset:3072 nt lds
    s_mov_b32 s93, 49152
    s_mov_b32 s91, 107520
    s_mov_b32 s55, 0
Lkv_69:
    s_waitcnt vmcnt(16)
    s_barrier
    s_add_u32 s49, s52, s91
    s_add_u32 s50, s59, s91
    s_add_u32 s48, s93, 0
    s_add_u32 m0, s49, 0
    s_nop 0
    buffer_load_dwordx4 v10, s[20:23], s48 offen offset:0 nt lds
    s_add_u32 m0, s49, 64
    s_nop 0
    buffer_load_dwordx4 v10, s[20:23], s48 offen offset:1024 nt lds
    s_add_u32 m0, s49, 128
    s_nop 0
    buffer_load_dwordx4 v10, s[20:23], s48 offen offset:2048 nt lds
    s_add_u32 m0, s49, 192
    s_nop 0
    buffer_load_dwordx4 v10, s[20:23], s48 offen offset:3072 nt lds
    s_add_u32 s48, s93, 4096
    s_add_u32 m0, s49, 4352
    s_nop 0
    buffer_load_dwordx4 v10, s[20:23], s48 offen offset:0 nt lds
    s_add_u32 m0, s49, 4416
    s_nop 0
    buffer_load_dwordx4 v10, s[20:23], s48 offen offset:1024 nt lds
    s_add_u32 m0, s49, 4480
    s_nop 0
    buffer_load_dwordx4 v10, s[20:23], s48 offen offset:2048 nt lds
    s_add_u32 m0, s49, 4544
    s_nop 0
    buffer_load_dwordx4 v10, s[20:23], s48 offen offset:3072 nt lds
    s_add_u32 s48, s93, 0
    s_add_u32 m0, s50, 17408
    s_nop 0
    buffer_load_dwordx4 v11, s[24:27], s48 offen offset:0 nt lds
    s_add_u32 m0, s50, 17536
    s_nop 0
    buffer_load_dwordx4 v11, s[24:27], s48 offen offset:1024 nt lds
    s_add_u32 m0, s50, 17664
    s_nop 0
    buffer_load_dwordx4 v11, s[24:27], s48 offen offset:2048 nt lds
    s_add_u32 m0, s50, 17792
    s_nop 0
    buffer_load_dwordx4 v11, s[24:27], s48 offen offset:3072 nt lds
    s_add_u32 s48, s93, 4096
    s_add_u32 m0, s50, 22016
    s_nop 0
    buffer_load_dwordx4 v11, s[24:27], s48 offen offset:0 nt lds
    s_add_u32 m0, s50, 22144
    s_nop 0
    buffer_load_dwordx4 v11, s[24:27], s48 offen offset:1024 nt lds
    s_add_u32 m0, s50, 22272
    s_nop 0
    buffer_load_dwordx4 v11, s[24:27], s48 offen offset:2048 nt lds
    s_add_u32 m0, s50, 22400
    s_nop 0
    buffer_load_dwordx4 v11, s[24:27], s48 offen offset:3072 nt lds
    s_add_u32 s93, s93, 16384
    s_add_u32 s91, s91, 35840
    s_cmp_eq_u32 s91, 143360
    s_cselect_b32 s91, 0, s91
    s_add_u32 s55, s55, 1
    s_cmp_lt_u32 s55, 13
    s_cbranch_scc1 Lkv_69
    s_waitcnt vmcnt(16)
    s_barrier
    s_cmp_lg_u32 s47, 0
    s_cbranch_scc1 Ldbg_70
    s_lshl_b32 s48, s45, 4
    v_mov_b32 v12, s48
    s_mov_b32 s51, 0
Ldbgw_71:
    global_load_dword v13, v12, s[16:17] sc1
    s_waitcnt vmcnt(0)
    v_readfirstlane_b32 s49, v13
    s_add_u32 s51, s51, 1
    s_cmp_gt_u32 s51, 200000
    s_cbranch_scc1 Ldbg_70
    s_cmp_lt_u32 s49, 16
    s_cbranch_scc1 Ldbgw_71
Ldbg_70:
    s_waitcnt vmcnt(0)
    s_barrier
    s_barrier
    s_barrier
    s_barrier
    v_lshlrev_b32 v24, 4, v1
    s_mul_i32 s48, s47, 6144
    s_add_u32 s48, s48, 143360
    v_add_u32 v20, s48, v24
    v_add_u32 v21, 3072, v20
    s_mul_i32 s48, s47, 71680
    s_add_u32 s48, s48, 32768
    v_add_u32 v22, s48, v24
    v_add_u32 v23, 35840, v22
    s_mul_i32 s48, s47, 6144
    v_add_u32 v24, s48, v24
    v_mov_b32 v26, 1
    s_lshl_b32 s48, s46, 3
    s_lshl_b32 s49, s47, 2
    s_add_u32 s48, s48, s49
    v_mov_b32 v25, 0x40000000
    s_nop 0
    v_writelane_b32 v25, s48, 0
    s_mov_b32 s93, 0
    s_barrier
Lsto_72:
    s_barrier
    ds_read_b128 v[64:67], v20 offset:0
    ds_read_b128 v[68:71], v20 offset:1024
    ds_read_b128 v[72:75], v20 offset:2048
    ds_read_b128 v[76:79], v21 offset:0
    ds_read_b128 v[80:83], v21 offset:1024
    ds_read_b128 v[84:87], v21 offset:2048
    s_mul_i32 s48, s93, 12288
    s_waitcnt lgkmcnt(5)
    buffer_store_dwordx4 v[64:67], v24, s[40:43], s48 offen sc0 sc1
    s_add_u32 s48, s48, 1024
    s_waitcnt lgkmcnt(4)
    buffer_store_dwordx4 v[68:71], v24, s[40:43], s48 offen sc0 sc1
    s_add_u32 s48, s48, 1024
    s_waitcnt lgkmcnt(3)
    buffer_store_dwordx4 v[72:75], v24, s[40:43], s48 offen sc0 sc1
    s_add_u32 s48, s48, 1024
    s_waitcnt lgkmcnt(2)
    buffer_store_dwordx4 v[76:79], v24, s[40:43], s48 offen sc0 sc1
    s_add_u32 s48, s48, 1024
    s_waitcnt lgkmcnt(1)
    buffer_store_dwordx4 v[80:83], v24, s[40:43], s48 offen sc0 sc1
    s_add_u32 s48, s48, 1024
    s_waitcnt lgkmcnt(0)
    buffer_store_dwordx4 v[84:87], v24, s[40:43], s48 offen sc0 sc1
    s_cmp_lt_u32 s93, 2
    s_cbranch_scc1 Lfl_73
    s_waitcnt vmcnt(12)
    s_sub_u32 s48, s93, 2
    s_lshl_b32 s48, s48, 7
    buffer_store_dword v26, v25, s[8:11], s48 offen sc0 sc1
Lfl_73:
    s_add_u32 s93, s93, 1
    s_barrier
    ds_read_b128 v[96:99], v22 offset:0
    ds_read_b128 v[100:103], v22 offset:1024
    ds_read_b128 v[104:107], v22 offset:2048
    ds_read_b128 v[108:111], v23 offset:0
    ds_read_b128 v[112:115], v23 offset:1024
    ds_read_b128 v[116:119], v23 offset:2048
    s_mul_i32 s48, s93, 12288
    s_waitcnt lgkmcnt(5)
    buffer_store_dwordx4 v[96:99], v24, s[40:43], s48 offen sc0 sc1
    s_add_u32 s48, s48, 1024
    s_waitcnt lgkmcnt(4)
    buffer_store_dwordx4 v[100:103], v24, s[40:43], s48 offen sc0 sc1
    s_add_u32 s48, s48, 1024
    s_waitcnt lgkmcnt(3)
    buffer_store_dwordx4 v[104:107], v24, s[40:43], s48 offen sc0 sc1
    s_add_u32 s48, s48, 1024
    s_waitcnt lgkmcnt(2)
    buffer_store_dwordx4 v[108:111], v24, s[40:43], s48 offen sc0 sc1
    s_add_u32 s48, s48, 1024
    s_waitcnt lgkmcnt(1)
    buffer_store_dwordx4 v[112:115], v24, s[40:43], s48 offen sc0 sc1
    s_add_u32 s48, s48, 1024
    s_waitcnt lgkmcnt(0)
    buffer_store_dwordx4 v[116:119], v24, s[40:43], s48 offen sc0 sc1
    s_cmp_lt_u32 s93, 2
    s_cbranch_scc1 Lfl_74
    s_waitcnt vmcnt(12)
    s_sub_u32 s48, s93, 2
    s_lshl_b32 s48, s48, 7
    buffer_store_dword v26, v25, s[8:11], s48 offen sc0 sc1
Lfl_74:
    s_add_u32 s93, s93, 1
    s_cmp_lt_u32 s93, 8
    s_cbranch_scc1 Lsto_72
    s_barrier
    ds_read_b128 v[64:67], v20 offset:0
    ds_read_b128 v[68:71], v20 offset:1024
    ds_read_b128 v[72:75], v20 offset:2048
    ds_read_b128 v[76:79], v21 offset:0
    ds_read_b128 v[80:83], v21 offset:1024
    ds_read_b128 v[84:87], v21 offset:2048
    s_mul_i32 s48, s93, 12288
    s_waitcnt lgkmcnt(5)
    buffer_store_dwordx4 v[64:67], v24, s[40:43], s48 offen sc0 sc1
    s_add_u32 s48, s48, 1024
    s_waitcnt lgkmcnt(4)
    buffer_store_dwordx4 v[68:71], v24, s[40:43], s48 offen sc0 sc1
    s_add_u32 s48, s48, 1024
    s_waitcnt lgkmcnt(3)
    buffer_store_dwordx4 v[72:75], v24, s[40:43], s48 offen sc0 sc1
    s_add_u32 s48, s48, 1024
    s_waitcnt lgkmcnt(2)
    buffer_store_dwordx4 v[76:79], v24, s[40:43], s48 offen sc0 sc1
    s_add_u32 s48, s48, 1024
    s_waitcnt lgkmcnt(1)
    buffer_store_dwordx4 v[80:83], v24, s[40:43], s48 offen sc0 sc1
    s_add_u32 s48, s48, 1024
    s_waitcnt lgkmcnt(0)
    buffer_store_dwordx4 v[84:87], v24, s[40:43], s48 offen sc0 sc1
    s_waitcnt vmcnt(12)
    s_sub_u32 s48, s93, 2
    s_lshl_b32 s48, s48, 7
    buffer_store_dword v26, v25, s[8:11], s48 offen sc0 sc1
Lfl_75:
    s_add_u32 s93, s93, 1
    s_waitcnt vmcnt(7)
    s_sub_u32 s48, s93, 2
    s_lshl_b32 s48, s48, 7
    buffer_store_dword v26, v25, s[8:11], s48 offen sc0 sc1
    s_waitcnt vmcnt(1)
    s_sub_u32 s48, s93, 1
    s_lshl_b32 s48, s48, 7
    buffer_store_dword v26, v25, s[8:11], s48 offen sc0 sc1
    s_cmp_eq_u32 s47, 0
    s_cselect_b32 s55, 7, 6
    s_branch L_reduce
L_reduce:
    s_mul_i32 s48, s55, 7
    s_cmp_eq_u32 s55, 7
    s_cselect_b32 s48, 48, s48
    s_mul_hi_u32 s50, s48, 715827883
    s_cmp_ge_u32 s55, 6
    s_cselect_b32 s101, 48, 56
    s_cselect_b32 s95, 0, -1
    v_lshlrev_b32 v9, 2, v1
    v_mov_b32 v7, 0x40000000
    s_lshl_b32 s50, s50, 7
    buffer_load_dword v11, v9, s[8:11], s50 offen sc1
    v_lshrrev_b32 v2, 3, v1
    v_add_u32 v2, s48, v2
    v_mul_u32_u24 v8, 10923, v2
    v_lshrrev_b32 v8, 16, v8
    v_mul_u32_u24 v5, 6, v8
    v_sub_u32 v2, v2, v5
    v_lshlrev_b32 v2, 3, v2
    v_and_b32 v5, 7, v1
    v_add_u32 v2, v2, v5
    s_mul_i32 s49, s46, 48
    v_add_u32 v2, s49, v2
    v_mul_u32_u24 v3, 12288, v8
    v_lshlrev_b32 v5, 4, v2
    v_add_u32 v3, v3, v5
    v_cmp_gt_u32 vcc, s101, v1
    s_nop 1
    v_cndmask_b32 v3, v7, v3, vcc
    v_lshrrev_b32 v4, 6, v2
    v_and_b32 v5, 63, v2
    v_cmp_le_u32 s[96:97], 6, v4
    s_nop 1
    v_cndmask_b32 v6, 0, 1, s[96:97]
    v_mul_u32_u24 v10, 6, v6
    v_sub_u32 v4, v4, v10
    v_lshlrev_b32 v4, 4, v4
    v_and_b32 v10, 15, v5
    v_add_u32 v4, v4, v10
    v_mul_u32_u24 v4, 1152, v4
    v_lshlrev_b32 v6, 6, v6
    v_lshrrev_b32 v5, 4, v5
    v_lshlrev_b32 v5, 3, v5
    v_add_u32 v4, v4, v6
    v_add_u32 v4, v4, v5
    s_and_b32 s49, s45, 7
    v_add_u32 v8, s49, v8
    v_cmp_le_u32 s[96:97], 9, v8
    s_nop 1
    v_cndmask_b32 v6, 0, 9, s[96:97]
    v_sub_u32 v8, v8, v6
    v_lshlrev_b32 v8, 7, v8
    v_add_u32 v4, v4, v8
    v_cndmask_b32 v4, v7, v4, vcc
    s_mov_b32 s51, 0
    s_branch Lpoll_77_chk
Lpoll_77:
    buffer_load_dword v11, v9, s[8:11], s50 offen sc1
Lpoll_77_chk:
    s_waitcnt vmcnt(0)
    v_cmp_eq_u32 vcc, 1, v11
    s_add_u32 s51, s51, 1
    s_cmp_gt_u32 s51, 200000
    s_cbranch_scc1 Lgiveup_76
    s_orn2_b32 vcc_hi, vcc_hi, s95
    s_cmp_eq_u64 vcc, -1
    s_cbranch_scc0 Lpoll_77
    s_mov_b32 s48, 0
    buffer_load_dwordx4 v[64:67], v3, s[4:7], s48 offen sc1
    s_add_u32 s48, s48, 110592
    buffer_load_dwordx4 v[68:71], v3, s[4:7], s48 offen sc1
    s_add_u32 s48, s48, 110592
    buffer_load_dwordx4 v[72:75], v3, s[4:7], s48 offen sc1
    s_add_u32 s48, s48, 110592
    buffer_load_dwordx4 v[76:79], v3, s[4:7], s48 offen sc1
    s_add_u32 s48, s48, 110592
    buffer_load_dwordx4 v[80:83], v3, s[4:7], s48 offen sc1
    s_add_u32 s48, s48, 110592
    buffer_load_dwordx4 v[84:87], v3, s[4:7], s48 offen sc1
    s_add_u32 s48, s48, 110592
    buffer_load_dwordx4 v[88:91], v3, s[4:7], s48 offen sc1
    s_add_u32 s48, s48, 110592
    buffer_load_dwordx4 v[92:95], v3, s[4:7], s48 offen sc1
    s_add_u32 s48, s48, 110592
    buffer_load_dwordx4 v[96:99], v3, s[4:7], s48 offen sc1
    s_add_u32 s48, s48, 110592
    buffer_load_dwordx4 v[100:103], v3, s[4:7], s48 offen sc1
    s_add_u32 s48, s48, 110592
    buffer_load_dwordx4 v[104:107], v3, s[4:7], s48 offen sc1
    s_add_u32 s48, s48, 110592
    buffer_load_dwordx4 v[108:111], v3, s[4:7], s48 offen sc1
    s_add_u32 s48, s48, 110592
    buffer_load_dwordx4 v[112:115], v3, s[4:7], s48 offen sc1
    s_add_u32 s48, s48, 110592
    buffer_load_dwordx4 v[116:119], v3, s[4:7], s48 offen sc1
    s_add_u32 s48, s48, 110592
    buffer_load_dwordx4 v[120:123], v3, s[4:7], s48 offen sc1
    s_add_u32 s48, s48, 110592
    buffer_load_dwordx4 v[124:127], v3, s[4:7], s48 offen sc1
    v_mov_b32 v12, 0x00003f80
    v_mov_b32 v13, 0x3f800000
    v_mov_b32 v48, 0
    v_mov_b32 v49, 0
    v_mov_b32 v50, 0
    v_mov_b32 v51, 0
    v_mov_b32 v52, 0
    v_mov_b32 v53, 0
    v_mov_b32 v54, 0
    v_mov_b32 v55, 0
    s_waitcnt vmcnt(15)
    v_dot2c_f32_bf16 v48, v64, v12
    v_dot2c_f32_bf16 v49, v64, v13
    v_dot2c_f32_bf16 v50, v65, v12
    v_dot2c_f32_bf16 v51, v65, v13
    v_dot2c_f32_bf16 v52, v66, v12
    v_dot2c_f32_bf16 v53, v66, v13
    v_dot2c_f32_bf16 v54, v67, v12
    v_dot2c_f32_bf16 v55, v67, v13
    s_waitcnt vmcnt(14)
    v_dot2c_f32_bf16 v48, v68, v12
    v_dot2c_f32_bf16 v49, v68, v13
    v_dot2c_f32_bf16 v50, v69, v12
    v_dot2c_f32_bf16 v51, v69, v13
    v_dot2c_f32_bf16 v52, v70, v12
    v_dot2c_f32_bf16 v53, v70, v13
    v_dot2c_f32_bf16 v54, v71, v12
    v_dot2c_f32_bf16 v55, v71, v13
    s_waitcnt vmcnt(13)
    v_dot2c_f32_bf16 v48, v72, v12
    v_dot2c_f32_bf16 v49, v72, v13
    v_dot2c_f32_bf16 v50, v73, v12
    v_dot2c_f32_bf16 v51, v73, v13
    v_dot2c_f32_bf16 v52, v74, v12
    v_dot2c_f32_bf16 v53, v74, v13
    v_dot2c_f32_bf16 v54, v75, v12
    v_dot2c_f32_bf16 v55, v75, v13
    s_waitcnt vmcnt(12)
    v_dot2c_f32_bf16 v48, v76, v12
    v_dot2c_f32_bf16 v49, v76, v13
    v_dot2c_f32_bf16 v50, v77, v12
    v_dot2c_f32_bf16 v51, v77, v13
    v_dot2c_f32_bf16 v52, v78, v12
    v_dot2c_f32_bf16 v53, v78, v13
    v_dot2c_f32_bf16 v54, v79, v12
    v_dot2c_f32_bf16 v55, v79, v13
    s_waitcnt vmcnt(11)
    v_dot2c_f32_bf16 v48, v80, v12
    v_dot2c_f32_bf16 v49, v80, v13
    v_dot2c_f32_bf16 v50, v81, v12
    v_dot2c_f32_bf16 v51, v81, v13
    v_dot2c_f32_bf16 v52, v82, v12
    v_dot2c_f32_bf16 v53, v82, v13
    v_dot2c_f32_bf16 v54, v83, v12
    v_dot2c_f32_bf16 v55, v83, v13
    s_waitcnt vmcnt(10)
    v_dot2c_f32_bf16 v48, v84, v12
    v_dot2c_f32_bf16 v49, v84, v13
    v_dot2c_f32_bf16 v50, v85, v12
    v_dot2c_f32_bf16 v51, v85, v13
    v_dot2c_f32_bf16 v52, v86, v12
    v_dot2c_f32_bf16 v53, v86, v13
    v_dot2c_f32_bf16 v54, v87, v12
    v_dot2c_f32_bf16 v55, v87, v13
    s_waitcnt vmcnt(9)
    v_dot2c_f32_bf16 v48, v88, v12
    v_dot2c_f32_bf16 v49, v88, v13
    v_dot2c_f32_bf16 v50, v89, v12
    v_dot2c_f32_bf16 v51, v89, v13
    v_dot2c_f32_bf16 v52, v90, v12
    v_dot2c_f32_bf16 v53, v90, v13
    v_dot2c_f32_bf16 v54, v91, v12
    v_dot2c_f32_bf16 v55, v91, v13
    s_waitcnt vmcnt(8)
    v_dot2c_f32_bf16 v48, v92, v12
    v_dot2c_f32_bf16 v49, v92, v13
    v_dot2c_f32_bf16 v50, v93, v12
    v_dot2c_f32_bf16 v51, v93, v13
    v_dot2c_f32_bf16 v52, v94, v12
    v_dot2c_f32_bf16 v53, v94, v13
    v_dot2c_f32_bf16 v54, v95, v12
    v_dot2c_f32_bf16 v55, v95, v13
    s_waitcnt vmcnt(7)
    v_dot2c_f32_bf16 v48, v96, v12
    v_dot2c_f32_bf16 v49, v96, v13
    v_dot2c_f32_bf16 v50, v97, v12
    v_dot2c_f32_bf16 v51, v97, v13
    v_dot2c_f32_bf16 v52, v98, v12
    v_dot2c_f32_bf16 v53, v98, v13
    v_dot2c_f32_bf16 v54, v99, v12
    v_dot2c_f32_bf16 v55, v99, v13
    s_waitcnt vmcnt(6)
    v_dot2c_f32_bf16 v48, v100, v12
    v_dot2c_f32_bf16 v49, v100, v13
    v_dot2c_f32_bf16 v50, v101, v12
    v_dot2c_f32_bf16 v51, v101, v13
    v_dot2c_f32_bf16 v52, v102, v12
    v_dot2c_f32_bf16 v53, v102, v13
    v_dot2c_f32_bf16 v54, v103, v12
    v_dot2c_f32_bf16 v55, v103, v13
    s_waitcnt vmcnt(5)
    v_dot2c_f32_bf16 v48, v104, v12
    v_dot2c_f32_bf16 v49, v104, v13
    v_dot2c_f32_bf16 v50, v105, v12
    v_dot2c_f32_bf16 v51, v105, v13
    v_dot2c_f32_bf16 v52, v106, v12
    v_dot2c_f32_bf16 v53, v106, v13
    v_dot2c_f32_bf16 v54, v107, v12
    v_dot2c_f32_bf16 v55, v107, v13
    s_waitcnt vmcnt(4)
    v_dot2c_f32_bf16 v48, v108, v12
    v_dot2c_f32_bf16 v49, v108, v13
    v_dot2c_f32_bf16 v50, v109, v12
    v_dot2c_f32_bf16 v51, v109, v13
    v_dot2c_f32_bf16 v52, v110, v12
    v_dot2c_f32_bf16 v53, v110, v13
    v_dot2c_f32_bf16 v54, v111, v12
    v_dot2c_f32_bf16 v55, v111, v13
    s_waitcnt vmcnt(3)
    v_dot2c_f32_bf16 v48, v112, v12
    v_dot2c_f32_bf16 v49, v112, v13
    v_dot2c_f32_bf16 v50, v113, v12
    v_dot2c_f32_bf16 v51, v113, v13
    v_dot2c_f32_bf16 v52, v114, v12
    v_dot2c_f32_bf16 v53, v114, v13
    v_dot2c_f32_bf16 v54, v115, v12
    v_dot2c_f32_bf16 v55, v115, v13
    s_waitcnt vmcnt(2)
    v_dot2c_f32_bf16 v48, v116, v12
    v_dot2c_f32_bf16 v49, v116, v13
    v_dot2c_f32_bf16 v50, v117, v12
    v_dot2c_f32_bf16 v51, v117, v13
    v_dot2c_f32_bf16 v52, v118, v12
    v_dot2c_f32_bf16 v53, v118, v13
    v_dot2c_f32_bf16 v54, v119, v12
    v_dot2c_f32_bf16 v55, v119, v13
    s_waitcnt vmcnt(1)
    v_dot2c_f32_bf16 v48, v120, v12
    v_dot2c_f32_bf16 v49, v120, v13
    v_dot2c_f32_bf16 v50, v121, v12
    v_dot2c_f32_bf16 v51, v121, v13
    v_dot2c_f32_bf16 v52, v122, v12
    v_dot2c_f32_bf16 v53, v122, v13
    v_dot2c_f32_bf16 v54, v123, v12
    v_dot2c_f32_bf16 v55, v123, v13
    s_waitcnt vmcnt(0)
    v_dot2c_f32_bf16 v48, v124, v12
    v_dot2c_f32_bf16 v49, v124, v13
    v_dot2c_f32_bf16 v50, v125, v12
    v_dot2c_f32_bf16 v51, v125, v13
    v_dot2c_f32_bf16 v52, v126, v12
    v_dot2c_f32_bf16 v53, v126, v13
    v_dot2c_f32_bf16 v54, v127, v12
    v_dot2c_f32_bf16 v55, v127, v13
    v_cvt_pk_bf16_f32 v56, v48, v49
    v_cvt_pk_bf16_f32 v57, v50, v51
    v_cvt_pk_bf16_f32 v58, v52, v53
    v_cvt_pk_bf16_f32 v59, v54, v55
    buffer_store_dwordx2 v[56:57], v4, s[12:15], 0 offen
    buffer_store_dwordx2 v[58:59], v4, s[12:15], 0 offen offset:32
Lgiveup_76:
    s_endpgm
L_k1_end:
    s_endpgm

.section .rodata,"a"
.p2align 6
.amdhsa_kernel standalone__gqa_block_cached__near_ridge_kernel
  .amdhsa_next_free_vgpr 256
  .amdhsa_next_free_sgpr 102
  .amdhsa_accum_offset 256
  .amdhsa_group_segment_fixed_size 0
  .amdhsa_kernarg_size 64
  .amdhsa_user_sgpr_count 2
  .amdhsa_user_sgpr_kernarg_segment_ptr 1
  .amdhsa_system_sgpr_workgroup_id_x 1
  .amdhsa_float_denorm_mode_32 3
.end_amdhsa_kernel
```
